```python
import torch

def _softmax(x, axis=-1):
    return torch.softmax(x, dim=axis)
def _gelu(x):
    return torch.nn.functional.gelu(x, approximate="tanh")
def _silu(x):
    return torch.nn.functional.silu(x)
def _sigmoid(x):
    return torch.sigmoid(x)
def _layernorm(x, axis=-1, eps=1e-5):
    m = x.mean(dim=axis, keepdim=True)
    v = x.var(dim=axis, keepdim=True, unbiased=False)
    return (x - m) / torch.sqrt(v + eps)
def _scatter_add(tgt, idx, src, axis=0):
    return tgt.clone().index_add_(axis, idx, src)
def _segment_sum(src, seg, n):
    out = torch.zeros((n,) + src.shape[1:], dtype=src.dtype)
    return out.index_add_(0, seg, src)
def _pad(x, pw):
    flat = tuple(v for pair in reversed(pw) for v in pair)
    return torch.nn.functional.pad(x, flat)

kernel_name = 'standalone__edge_featured_mpnn_gatedgcn__graph'

def setup_inputs():

    _w = (lambda a: (lambda t: t.to(torch.bfloat16) if t.is_floating_point() else t)(torch.as_tensor(a)))
    N, deg, D, De = 12500, 32, 128, max(4, 1)
    E = N * deg
    return {
        "x": _w((lambda *s: torch.randn(*s, dtype=torch.bfloat16) * 0.4)(N, D)),
        "e_attr": _w((lambda *s: torch.randn(*s, dtype=torch.bfloat16) * 0.8)(E, De)),
        "src": _w((lambda lo, hi, *s: torch.randint(lo, hi, s))(0, N, E).to(torch.int64)),
        "dst": _w((lambda lo, hi, *s: torch.randint(lo, hi, s))(0, N, E).to(torch.int64)),
        "w_a": _w((lambda *s: torch.randn(*s, dtype=torch.bfloat16) * 0.4)(D, D)),
        "w_b": _w((lambda *s: torch.randn(*s, dtype=torch.bfloat16) * 0.4)(D, D)),
        "w_c": _w((lambda *s: torch.randn(*s, dtype=torch.bfloat16) * 0.8)(De, D)),
        "w_u": _w((lambda *s: torch.randn(*s, dtype=torch.bfloat16) * 0.05)(D, D)),
        "w_v": _w((lambda *s: torch.randn(*s, dtype=torch.bfloat16) * 0.05)(D, D)),
    }

def reference(x, e_attr, src, dst, w_a, w_b, w_c, w_u, w_v):
    N, D = x.shape
    hv = x @ w_v
    g = x[dst] @ w_a + x[src] @ w_b + e_attr @ w_c
    eta = _sigmoid(g)
    denom = _segment_sum(eta, dst, N) + 1e-6
    eta_n = eta / denom[dst]
    agg = _segment_sum(eta_n * hv[src], dst, N)
    z = x @ w_u + agg
    relu_z = torch.where(z > 0, z, 0 * z)
    return x + relu_z
```

```asm
; @launch grid=(256,1,1) block=(1024,1,1) lds=161280
.amdgcn_target "amdgcn-amd-amdhsa--gfx950"
.text
.globl standalone__edge_featured_mpnn_gatedgcn__graph_kernel
.p2align 8
.type standalone__edge_featured_mpnn_gatedgcn__graph_kernel,@function
standalone__edge_featured_mpnn_gatedgcn__graph_kernel:
    s_cmp_ge_u32 s2, 256
    s_cbranch_scc1 K2_END
    s_load_dwordx16 s[4:19], s[0:1], 0
    s_load_dwordx8 s[20:27], s[0:1], 64
    s_memrealtime s[72:73]
    v_lshrrev_b32 v13, 6, v0
    v_lshlrev_b32 v8, 4, v0
    s_bfe_u32 s53, s2, 0x10002
    s_lshr_b32 s3, s2, 3
    s_and_b32 s54, s2, 3
    s_lshl_b32 s54, s54, 5
    s_or_b32 s54, s54, s3
    v_readfirstlane_b32 s52, v13
    v_and_b32 v1, 63, v0
    v_mov_b64 v[116:117], 0
    v_mov_b64 v[118:119], 0
    s_mul_i32 s56, s53, 3211264
    s_mul_i32 s55, s54, 25088
    s_lshl_b32 s63, s53, 7
    s_add_u32 s57, s55, s63
    s_cmp_ge_u32 s52, 8
    s_cbranch_scc1 F_GEMM
    s_setprio 3
    v_lshlrev_b32 v56, 5, v0
    s_movk_i32 s58, 400
    v_cmp_gt_u32 s[70:71], s58, v0
    s_cmp_lt_u32 s2, 250
    s_cselect_b64 s[70:71], s[70:71], 0
    s_mul_i32 s58, s2, 6400
    s_lshl_b32 s59, s58, 1
    s_or_b32 s3, s2, s52
    s_waitcnt lgkmcnt(0)
    s_cmp_lg_u32 s3, 0
    s_cbranch_scc1 F_NOTFIRST
    s_or_b32 s72, s72, 1
    s_lshl_b32 s73, s73, 22
    s_mov_b32 s28, s24
    s_and_b32 s29, s25, 0xffff
    s_mov_b32 s30, 8
    s_mov_b32 s31, 0x00020000
    v_mov_b32 v124, s72
    v_mov_b32 v125, s73
    s_mov_b64 exec, 1
    buffer_store_dwordx2 v[124:125], v119, s[28:31], 0 offen sc1
F_NOTFIRST:
    s_mov_b64 exec, s[70:71]
    s_mov_b32 s28, s10
    s_and_b32 s29, s11, 0xffff
    s_mov_b32 s30, 1600000
    s_mov_b32 s31, 0x00020000
    buffer_load_dwordx4 v[16:19], v8, s[28:31], s58 offen
    s_mov_b32 s32, s8
    s_and_b32 s33, s9, 0xffff
    s_mov_b32 s34, 1600000
    s_mov_b32 s35, 0x00020000
    s_mov_b32 s36, s6
    s_and_b32 s37, s7, 0xffff
    s_mov_b32 s38, 3200000
    s_mov_b32 s39, 0x00020000
    buffer_load_dwordx4 v[20:23], v8, s[32:35], s58 offen
    buffer_load_dwordx4 v[24:27], v56, s[36:39], s59 offen
    buffer_load_dwordx4 v[28:31], v56, s[36:39], s59 offen offset:16
    s_mov_b64 exec, -1
    s_movk_i32 s58, 128
    v_cmp_gt_u32 vcc, s58, v0
    v_mov_b32 v52, 1
    v_lshlrev_b32 v53, 3, v1
    s_mov_b64 exec, vcc
    ds_write_b128 v8, v[116:119]
    s_mov_b64 exec, -1
    s_waitcnt lgkmcnt(0)
    s_barrier
    v_lshrrev_b32 v13, 3, v0
    v_and_b32 v115, 7, v0
    v_lshlrev_b32 v9, 4, v115
    v_lshl_or_b32 v9, v13, 8, v9
    s_lshl_b32 s58, s53, 3
    v_or_b32 v115, s58, v115
    v_and_b32 v4, 15, v13
    v_xor_b32 v115, v115, v4
    v_lshlrev_b32 v115, 4, v115
    v_lshl_or_b32 v4, v13, 8, v115
    v_add_u32 v4, 2560, v4
    s_movk_i32 s58, -98
    s_mov_b32 s28, s24
    s_and_b32 s29, s25, 0xffff
    s_mov_b32 s30, 8
    s_mov_b32 s31, 0x00020000
    s_mov_b64 exec, s[70:71]
    s_waitcnt vmcnt(3)
    v_mul_u32_u24 v40, 10700, v16
    v_lshrrev_b32 v40, 20, v40
    v_lshlrev_b32 v32, 2, v40
    ds_add_rtn_u32 v36, v32, v52 offset:0
    v_mul_u32_u24 v41, 10700, v17
    v_lshrrev_b32 v41, 20, v41
    v_lshlrev_b32 v33, 2, v41
    ds_add_rtn_u32 v37, v33, v52 offset:0
    v_mul_u32_u24 v42, 10700, v18
    v_lshrrev_b32 v42, 20, v42
    v_lshlrev_b32 v34, 2, v42
    ds_add_rtn_u32 v38, v34, v52 offset:0
    v_mul_u32_u24 v43, 10700, v19
    v_lshrrev_b32 v43, 20, v43
    v_lshlrev_b32 v35, 2, v43
    ds_add_rtn_u32 v39, v35, v52 offset:0
    v_mad_i32_i24 v40, v40, s58, v16
    v_mad_i32_i24 v41, v41, s58, v17
    v_mad_i32_i24 v42, v42, s58, v18
    v_mad_i32_i24 v43, v43, s58, v19
    s_mov_b64 exec, -1
    s_waitcnt lgkmcnt(0)
    v_mov_b32 v124, 1560
    v_mov_b32 v125, 1
    s_mov_b64 exec, 1
    ds_add_u32 v124, v125
    s_mov_b64 exec, -1
    s_mov_b32 s65, 480000
F_SYNC1:
    ds_read_b32 v125, v124
    s_sub_u32 s65, s65, 1
    s_cmp_eq_u32 s65, 0
    s_cbranch_scc1 K2_END
    s_waitcnt lgkmcnt(0)
    v_readfirstlane_b32 s3, v125
    s_cmp_lt_u32 s3, 8
    s_cbranch_scc1 F_SYNC1
    ds_read_b64 v[44:45], v53 offset:0
    s_waitcnt lgkmcnt(0)
    v_add_u32 v46, v44, v45
    s_nop 1
    v_add_u32_dpp v46, v46, v46 row_shr:1 row_mask:0xf bank_mask:0xf bound_ctrl:0
    s_nop 1
    v_add_u32_dpp v46, v46, v46 row_shr:2 row_mask:0xf bank_mask:0xf bound_ctrl:0
    s_nop 1
    v_add_u32_dpp v46, v46, v46 row_shr:4 row_mask:0xf bank_mask:0xf bound_ctrl:0
    s_nop 1
    v_add_u32_dpp v46, v46, v46 row_shr:8 row_mask:0xf bank_mask:0xf bound_ctrl:0
    s_nop 1
    v_add_u32_dpp v46, v46, v46 row_bcast:15 row_mask:0xa bank_mask:0xf
    s_nop 1
    v_add_u32_dpp v46, v46, v46 row_bcast:31 row_mask:0xc bank_mask:0xf
    v_mov_b32 v48, 31232
    v_sub_u32 v51, v46, v45
    v_sub_u32 v50, v51, v44
    v_mad_u32_u24 v49, v51, 12, v48
    v_mad_u32_u24 v48, v50, 12, v48
    ds_write_b64 v53, v[48:49] offset:512
    s_mov_b64 exec, s[70:71]
    ds_read_b32 v32, v32 offset:512
    ds_read_b32 v33, v33 offset:512
    ds_read_b32 v34, v34 offset:512
    ds_read_b32 v35, v35 offset:512
    s_waitcnt vmcnt(2)
    v_lshl_or_b32 v40, v40, 24, v20
    v_lshl_or_b32 v41, v41, 24, v21
    v_lshl_or_b32 v42, v42, 24, v22
    v_lshl_or_b32 v43, v43, 24, v23
    s_waitcnt vmcnt(0)
    s_waitcnt lgkmcnt(3)
    v_mad_u32_u24 v32, v36, 12, v32
    ds_write2_b32 v32, v24, v25 offset0:0 offset1:1
    ds_write_b32 v32, v40 offset:8
    s_waitcnt lgkmcnt(4)
    v_mad_u32_u24 v33, v37, 12, v33
    ds_write2_b32 v33, v26, v27 offset0:0 offset1:1
    ds_write_b32 v33, v41 offset:8
    s_waitcnt lgkmcnt(5)
    v_mad_u32_u24 v34, v38, 12, v34
    ds_write2_b32 v34, v28, v29 offset0:0 offset1:1
    ds_write_b32 v34, v42 offset:8
    s_waitcnt lgkmcnt(6)
    v_mad_u32_u24 v35, v39, 12, v35
    ds_write2_b32 v35, v30, v31 offset0:0 offset1:1
    ds_write_b32 v35, v43 offset:8
    s_mov_b64 exec, -1
    buffer_load_dwordx2 v[68:69], v119, s[28:31], 0 offen sc1
    s_mul_i32 s58, s2, 19200
    s_add_u32 s58, s58, 8388608
    s_cmp_lt_u32 s2, 250
    s_cselect_b32 s59, 19200, 0
    s_add_u32 s28, s26, s58
    s_addc_u32 s29, s27, 0
    s_and_b32 s29, s29, 0xffff
    s_mov_b32 s30, s59
    s_mov_b32 s31, 0x00020000
    s_movk_i32 s58, 0x2000
    s_movk_i32 s59, 0x4000
    s_waitcnt lgkmcnt(0)
    v_mov_b32 v124, 1564
    v_mov_b32 v125, 1
    s_mov_b64 exec, 1
    ds_add_u32 v124, v125
    s_mov_b64 exec, -1
    s_mov_b32 s65, 480000
F_SYNC2:
    ds_read_b32 v125, v124
    s_sub_u32 s65, s65, 1
    s_cmp_eq_u32 s65, 0
    s_cbranch_scc1 K2_END
    s_waitcnt lgkmcnt(0)
    v_readfirstlane_b32 s3, v125
    s_cmp_lt_u32 s3, 8
    s_cbranch_scc1 F_SYNC2
    ds_read_b128 v[56:59], v8 offset:31232
    ds_read_b128 v[60:63], v8 offset:39424
    ds_read_b128 v[64:67], v8 offset:47616
    s_waitcnt lgkmcnt(2)
    buffer_store_dwordx4 v[56:59], v8, s[28:31], 0 offen sc1
    s_waitcnt lgkmcnt(1)
    buffer_store_dwordx4 v[60:63], v8, s[28:31], s58 offen sc1
    s_waitcnt lgkmcnt(0)
    buffer_store_dwordx4 v[64:67], v8, s[28:31], s59 offen sc1
    v_lshl_or_b32 v50, v44, 11, v50
    v_lshl_or_b32 v52, v45, 11, v51
    s_waitcnt vmcnt(3)
    v_readfirstlane_b32 s72, v68
    v_readfirstlane_b32 s73, v69
    s_mov_b32 s59, 30000
F_NONCE3:
    s_cmp_lg_u32 s72, 0
    s_cbranch_scc1 F_NONCED3
    s_mov_b32 s28, s24
    s_and_b32 s29, s25, 0xffff
    s_mov_b32 s30, 8
    s_mov_b32 s31, 0x00020000
    v_mov_b32 v13, 0
    buffer_load_dwordx2 v[124:125], v13, s[28:31], 0 offen sc1
    s_waitcnt vmcnt(0)
    v_readfirstlane_b32 s72, v124
    v_readfirstlane_b32 s73, v125
    s_sub_u32 s59, s59, 1
    s_cmp_eq_u32 s59, 0
    s_cbranch_scc1 K2_END
    s_branch F_NONCE3
F_NONCED3:
    s_waitcnt vmcnt(0)
    s_mov_b64 exec, 1
    v_mov_b32 v124, 1552
    v_mov_b32 v125, 1
    ds_add_rtn_u32 v125, v124, v125
    s_waitcnt lgkmcnt(0)
    v_readfirstlane_b32 s58, v125
    s_mov_b64 exec, -1
    s_cmp_lg_u32 s58, 7
    s_cbranch_scc1 F_PDONE
    s_cmp_ge_u32 s2, 250
    s_cbranch_scc1 F_PDONE
    s_add_u32 s28, s26, 0x1000000
    s_addc_u32 s29, s27, 0
    s_and_b32 s29, s29, 0xffff
    s_mov_b32 s30, 256000
    s_mov_b32 s31, 0x00020000
    v_or_b32 v50, s73, v50
    v_mov_b32 v51, s72
    v_or_b32 v52, s73, v52
    v_mov_b32 v53, s72
    v_lshlrev_b32 v13, 4, v1
    s_lshl_b32 s58, s2, 10
    buffer_store_dwordx4 v[50:53], v13, s[28:31], s58 offen sc1
F_PDONE:
    s_setprio 0
    v_mov_b32 v124, 1572
    s_mov_b32 s65, 480000
F_SYNC4:
    s_sleep 2
    ds_read_b32 v125, v124
    s_sub_u32 s65, s65, 1
    s_cmp_eq_u32 s65, 0
    s_cbranch_scc1 K2_END
    s_waitcnt lgkmcnt(0)
    v_readfirstlane_b32 s3, v125
    s_cmp_lt_u32 s3, 7
    s_cbranch_scc1 F_SYNC4
    ds_read_b128 v[4:7], v4
    s_branch F_COMMON
F_GEMM:
    s_setprio 2
    s_cmp_lg_u32 s52, 8
    s_cbranch_scc1 F_NOIPF
    s_getpc_b64 s[58:59]
F_PC:
    s_sub_u32 s58, s58, F_PC-standalone__edge_featured_mpnn_gatedgcn__graph_kernel
    s_subb_u32 s59, s59, 0
    v_lshlrev_b32 v20, 7, v1
    v_min_u32 v21, F_LAST-standalone__edge_featured_mpnn_gatedgcn__graph_kernel-8192-4, v20
    global_load_dword v22, v20, s[58:59]
    s_add_u32 s58, s58, 8192
    s_addc_u32 s59, s59, 0
    global_load_dword v23, v21, s[58:59]
F_NOIPF:
    v_lshrrev_b32 v98, 3, v1
    v_and_b32 v99, 2, v98
    v_and_b32 v96, 7, v1
    v_xor_b32 v96, v96, v99
    v_lshlrev_b32 v96, 4, v96
    v_lshl_or_b32 v96, v98, 8, v96
    v_lshrrev_b32 v98, 4, v1
    v_and_b32 v99, 15, v1
    v_xor_b32 v97, v99, v98
    v_lshlrev_b32 v97, 4, v97
    v_lshl_or_b32 v97, v98, 8, v97
    s_add_u32 s62, s55, 25088
    s_min_u32 s62, s62, 3200000
    s_and_b32 s60, s52, 7
    v_xor_b32 v98, 64, v96
    s_lshl_b32 s61, s60, 12
    s_add_u32 s59, s61, 2560
    s_add_u32 s58, s61, s55
    s_lshr_b32 s64, s60, 1
    s_lshl_b32 s68, s64, 13
    s_add_u32 s68, s68, s63
    s_lshl_b32 s69, s64, 12
    s_and_b32 s64, s60, 1
    s_lshl_b32 s64, s64, 14
    s_add_u32 s69, s69, s64
    s_add_u32 s69, s69, 93440
    s_cmp_lt_u32 s52, 15
    s_cselect_b64 s[70:71], -1, 0
    s_waitcnt lgkmcnt(0)
    s_bitcmp1_b32 s52, 0
    s_cselect_b64 s[66:67], s[20:21], s[14:15]
    s_cselect_b64 s[74:75], s[18:19], s[12:13]
    s_mov_b32 s28, s66
    s_and_b32 s29, s67, 0xffff
    s_mov_b32 s30, 32768
    s_mov_b32 s31, 0x00020000
    s_mov_b32 s32, s4
    s_and_b32 s33, s5, 0xffff
    s_mov_b32 s34, s62
    s_mov_b32 s35, 0x00020000
    s_mov_b32 s36, s24
    s_and_b32 s37, s25, 0xffff
    s_mov_b32 s38, 8
    s_mov_b32 s39, 0x00020000
    s_barrier
    s_mov_b32 s44, s74
    s_and_b32 s45, s75, 0xffff
    s_mov_b32 s46, 32768
    s_mov_b32 s47, 0x00020000
    s_add_u32 s64, s69, 32768
    s_mov_b64 exec, s[70:71]
    s_mov_b32 m0, s59
    s_add_u32 s59, s59, 1024
    buffer_load_dwordx4 v97, s[32:35], s58 offen lds
    s_mov_b64 exec, -1
    s_add_u32 s58, s58, 1024
    v_xor_b32 v97, 64, v97
    s_mov_b32 m0, s69
    s_add_u32 s69, s69, 1024
    buffer_load_dwordx4 v96, s[28:31], s68 offen lds
    s_mov_b32 m0, s64
    s_add_u32 s64, s64, 1024
    buffer_load_dwordx4 v96, s[44:47], s68 offen lds
    s_add_u32 s68, s68, 2048
    s_mov_b64 exec, s[70:71]
    s_mov_b32 m0, s59
    s_add_u32 s59, s59, 1024
    buffer_load_dwordx4 v97, s[32:35], s58 offen lds
    s_mov_b64 exec, -1
    s_add_u32 s58, s58, 1024
    v_xor_b32 v97, 192, v97
    s_mov_b32 m0, s69
    s_add_u32 s69, s69, 1024
    buffer_load_dwordx4 v98, s[28:31], s68 offen lds
    s_mov_b32 m0, s64
    s_add_u32 s64, s64, 1024
    buffer_load_dwordx4 v98, s[44:47], s68 offen lds
    s_add_u32 s68, s68, 2048
    s_mov_b64 exec, s[70:71]
    s_mov_b32 m0, s59
    s_add_u32 s59, s59, 1024
    buffer_load_dwordx4 v97, s[32:35], s58 offen lds
    s_mov_b64 exec, -1
    s_add_u32 s58, s58, 1024
    v_xor_b32 v97, 64, v97
    s_mov_b32 m0, s69
    s_add_u32 s69, s69, 1024
    buffer_load_dwordx4 v96, s[28:31], s68 offen lds
    s_mov_b32 m0, s64
    s_add_u32 s64, s64, 1024
    buffer_load_dwordx4 v96, s[44:47], s68 offen lds
    s_add_u32 s68, s68, 2048
    s_mov_b64 exec, s[70:71]
    s_mov_b32 m0, s59
    s_add_u32 s59, s59, 1024
    buffer_load_dwordx4 v97, s[32:35], s58 offen lds
    s_mov_b64 exec, -1
    s_mov_b32 m0, s69
    s_add_u32 s69, s69, 1024
    buffer_load_dwordx4 v98, s[28:31], s68 offen lds
    s_mov_b32 m0, s64
    s_add_u32 s64, s64, 1024
    buffer_load_dwordx4 v98, s[44:47], s68 offen lds
    s_add_u32 s68, s68, 2048
    buffer_load_dwordx2 v[68:69], v119, s[36:39], 0 offen sc1
    s_cmp_lg_u32 s52, 15
    s_cbranch_scc1 F_NOWC
    s_mov_b32 s40, s16
    s_and_b32 s41, s17, 0xffff
    s_mov_b32 s42, 1024
    s_mov_b32 s43, 0x00020000
    v_lshlrev_b32 v13, 1, v1
    buffer_load_ushort v120, v13, s[40:43], s63 offen offset:0
    buffer_load_ushort v121, v13, s[40:43], s63 offen offset:256
    buffer_load_ushort v122, v13, s[40:43], s63 offen offset:512
    buffer_load_ushort v123, v13, s[40:43], s63 offen offset:768
    s_mov_b32 s58, 0xbfb8aa3b
    v_lshlrev_b32 v13, 3, v1
    s_waitcnt vmcnt(0)
    v_lshlrev_b32 v120, 16, v120
    v_mul_f32 v120, s58, v120
    v_lshlrev_b32 v121, 16, v121
    v_mul_f32 v121, s58, v121
    v_lshlrev_b32 v122, 16, v122
    v_mul_f32 v122, s58, v122
    v_lshlrev_b32 v123, 16, v123
    v_mul_f32 v123, s58, v123
    v_cvt_pk_bf16_f32 v120, v120, v121
    v_cvt_pk_bf16_f32 v121, v122, v123
    ds_write_b64 v13, v[120:121] offset:50688
F_NOWC:
    v_lshrrev_b32 v13, 3, v0
    v_and_b32 v115, 7, v0
    v_lshlrev_b32 v9, 4, v115
    v_lshl_or_b32 v9, v13, 8, v9
    s_lshl_b32 s58, s53, 3
    v_or_b32 v115, s58, v115
    v_and_b32 v4, 15, v13
    v_xor_b32 v115, v115, v4
    v_lshlrev_b32 v115, 4, v115
    v_lshl_or_b32 v4, v13, 8, v115
    v_add_u32 v4, 2560, v4
    v_lshrrev_b32 v117, 4, v1
    v_and_b32 v118, 15, v1
    v_xor_b32 v116, v118, v117
    v_lshlrev_b32 v116, 4, v116
    v_lshl_or_b32 v116, v118, 8, v116
    v_bfe_u32 v118, v1, 2, 2
    v_lshl_add_u32 v112, v117, 3, v118
    v_lshlrev_b32 v112, 7, v112
    v_and_b32 v118, 2, v118
    v_and_b32 v117, 1, v117
    v_lshl_or_b32 v118, v117, 2, v118
    v_bfe_u32 v117, v1, 1, 1
    v_xor_b32 v117, v117, v118
    v_lshl_or_b32 v112, v117, 4, v112
    v_and_b32 v117, 1, v1
    v_lshl_or_b32 v112, v117, 3, v112
    s_add_u32 s58, s61, 2560
    v_add_u32 v116, s58, v116
    v_add_u32 v112, 93440, v112
    v_xor_b32 v113, 32, v112
    v_xor_b32 v114, 64, v112
    v_xor_b32 v115, 96, v112
    s_waitcnt vmcnt(0)
    v_readfirstlane_b32 s72, v68
    v_readfirstlane_b32 s73, v69
    ds_read_b128 v[16:19], v116
    v_xor_b32 v117, 64, v116
    ds_read_b128 v[20:23], v117
    v_xor_b32 v117, 128, v116
    ds_read_b128 v[24:27], v117
    v_xor_b32 v117, 192, v116
    ds_read_b128 v[28:31], v117
    s_waitcnt lgkmcnt(4)
    v_mov_b32 v124, 1568
    v_mov_b32 v125, 1
    s_mov_b64 exec, 1
    ds_add_u32 v124, v125
    s_mov_b64 exec, -1
    s_mov_b32 s65, 480000
F_SYNC5:
    ds_read_b32 v125, v124
    s_sub_u32 s65, s65, 1
    s_cmp_eq_u32 s65, 0
    s_cbranch_scc1 K2_END
    s_waitcnt lgkmcnt(0)
    v_readfirstlane_b32 s3, v125
    s_cmp_lt_u32 s3, 8
    s_cbranch_scc1 F_SYNC5
    s_cmp_eq_u32 s52, 15
    s_cbranch_scc1 F_NOTABLE
    ds_read_b64_tr_b16 v[32:33], v112 offset:0
    ds_read_b64_tr_b16 v[34:35], v112 offset:512
    ds_read_b64_tr_b16 v[36:37], v113 offset:0
    ds_read_b64_tr_b16 v[38:39], v113 offset:512
    ds_read_b64_tr_b16 v[40:41], v114 offset:0
    ds_read_b64_tr_b16 v[42:43], v114 offset:512
    ds_read_b64_tr_b16 v[44:45], v115 offset:0
    ds_read_b64_tr_b16 v[46:47], v115 offset:512
    ds_read_b64_tr_b16 v[96:97], v112 offset:16384
    ds_read_b64_tr_b16 v[98:99], v112 offset:16896
    ds_read_b64_tr_b16 v[100:101], v113 offset:16384
    ds_read_b64_tr_b16 v[102:103], v113 offset:16896
    ds_read_b64_tr_b16 v[104:105], v114 offset:16384
    ds_read_b64_tr_b16 v[106:107], v114 offset:16896
    s_waitcnt lgkmcnt(12)
    v_mfma_f32_16x16x32_bf16 v[48:51], v[16:19], v[32:35], 0
    ds_read_b64_tr_b16 v[108:109], v115 offset:16384
    ds_read_b64_tr_b16 v[110:111], v115 offset:16896
    s_waitcnt lgkmcnt(12)
    v_mfma_f32_16x16x32_bf16 v[52:55], v[16:19], v[36:39], 0
    ds_read_b64_tr_b16 v[32:33], v112 offset:4096
    ds_read_b64_tr_b16 v[34:35], v112 offset:4608
    s_waitcnt lgkmcnt(12)
    v_mfma_f32_16x16x32_bf16 v[56:59], v[16:19], v[40:43], 0
    ds_read_b64_tr_b16 v[36:37], v113 offset:4096
    ds_read_b64_tr_b16 v[38:39], v113 offset:4608
    s_waitcnt lgkmcnt(12)
    v_mfma_f32_16x16x32_bf16 v[60:63], v[16:19], v[44:47], 0
    ds_read_b64_tr_b16 v[40:41], v114 offset:4096
    ds_read_b64_tr_b16 v[42:43], v114 offset:4608
    s_waitcnt lgkmcnt(12)
    v_mfma_f32_16x16x32_bf16 v[64:67], v[16:19], v[96:99], 0
    ds_read_b64_tr_b16 v[44:45], v115 offset:4096
    ds_read_b64_tr_b16 v[46:47], v115 offset:4608
    s_waitcnt lgkmcnt(12)
    v_mfma_f32_16x16x32_bf16 v[68:71], v[16:19], v[100:103], 0
    ds_read_b64_tr_b16 v[96:97], v112 offset:20480
    ds_read_b64_tr_b16 v[98:99], v112 offset:20992
    s_waitcnt lgkmcnt(12)
    v_mfma_f32_16x16x32_bf16 v[72:75], v[16:19], v[104:107], 0
    ds_read_b64_tr_b16 v[100:101], v113 offset:20480
    ds_read_b64_tr_b16 v[102:103], v113 offset:20992
    s_waitcnt lgkmcnt(12)
    v_mfma_f32_16x16x32_bf16 v[76:79], v[16:19], v[108:111], 0
    ds_read_b64_tr_b16 v[104:105], v114 offset:20480
    ds_read_b64_tr_b16 v[106:107], v114 offset:20992
    s_waitcnt lgkmcnt(12)
    v_mfma_f32_16x16x32_bf16 v[48:51], v[20:23], v[32:35], v[48:51]
    ds_read_b64_tr_b16 v[108:109], v115 offset:20480
    ds_read_b64_tr_b16 v[110:111], v115 offset:20992
    s_waitcnt lgkmcnt(12)
    v_mfma_f32_16x16x32_bf16 v[52:55], v[20:23], v[36:39], v[52:55]
    ds_read_b64_tr_b16 v[32:33], v112 offset:8192
    ds_read_b64_tr_b16 v[34:35], v112 offset:8704
    s_waitcnt lgkmcnt(12)
    v_mfma_f32_16x16x32_bf16 v[56:59], v[20:23], v[40:43], v[56:59]
    ds_read_b64_tr_b16 v[36:37], v113 offset:8192
    ds_read_b64_tr_b16 v[38:39], v113 offset:8704
    s_waitcnt lgkmcnt(12)
    v_mfma_f32_16x16x32_bf16 v[60:63], v[20:23], v[44:47], v[60:63]
    ds_read_b64_tr_b16 v[40:41], v114 offset:8192
    ds_read_b64_tr_b16 v[42:43], v114 offset:8704
    s_waitcnt lgkmcnt(12)
    v_mfma_f32_16x16x32_bf16 v[64:67], v[20:23], v[96:99], v[64:67]
    ds_read_b64_tr_b16 v[44:45], v115 offset:8192
    ds_read_b64_tr_b16 v[46:47], v115 offset:8704
    s_waitcnt lgkmcnt(12)
    v_mfma_f32_16x16x32_bf16 v[68:71], v[20:23], v[100:103], v[68:71]
    ds_read_b64_tr_b16 v[96:97], v112 offset:24576
    ds_read_b64_tr_b16 v[98:99], v112 offset:25088
    s_waitcnt lgkmcnt(12)
    v_mfma_f32_16x16x32_bf16 v[72:75], v[20:23], v[104:107], v[72:75]
    ds_read_b64_tr_b16 v[100:101], v113 offset:24576
    ds_read_b64_tr_b16 v[102:103], v113 offset:25088
    s_waitcnt lgkmcnt(12)
    v_mfma_f32_16x16x32_bf16 v[76:79], v[20:23], v[108:111], v[76:79]
    ds_read_b64_tr_b16 v[104:105], v114 offset:24576
    ds_read_b64_tr_b16 v[106:107], v114 offset:25088
    s_waitcnt lgkmcnt(12)
    v_mfma_f32_16x16x32_bf16 v[48:51], v[24:27], v[32:35], v[48:51]
    ds_read_b64_tr_b16 v[108:109], v115 offset:24576
    ds_read_b64_tr_b16 v[110:111], v115 offset:25088
    s_waitcnt lgkmcnt(12)
    v_mfma_f32_16x16x32_bf16 v[52:55], v[24:27], v[36:39], v[52:55]
    ds_read_b64_tr_b16 v[32:33], v112 offset:12288
    ds_read_b64_tr_b16 v[34:35], v112 offset:12800
    s_waitcnt lgkmcnt(12)
    v_mfma_f32_16x16x32_bf16 v[56:59], v[24:27], v[40:43], v[56:59]
    ds_read_b64_tr_b16 v[36:37], v113 offset:12288
    ds_read_b64_tr_b16 v[38:39], v113 offset:12800
    s_waitcnt lgkmcnt(12)
    v_mfma_f32_16x16x32_bf16 v[60:63], v[24:27], v[44:47], v[60:63]
    ds_read_b64_tr_b16 v[40:41], v114 offset:12288
    ds_read_b64_tr_b16 v[42:43], v114 offset:12800
    s_waitcnt lgkmcnt(12)
    v_mfma_f32_16x16x32_bf16 v[64:67], v[24:27], v[96:99], v[64:67]
    ds_read_b64_tr_b16 v[44:45], v115 offset:12288
    ds_read_b64_tr_b16 v[46:47], v115 offset:12800
    s_waitcnt lgkmcnt(12)
    v_mfma_f32_16x16x32_bf16 v[68:71], v[24:27], v[100:103], v[68:71]
    ds_read_b64_tr_b16 v[96:97], v112 offset:28672
    ds_read_b64_tr_b16 v[98:99], v112 offset:29184
    s_waitcnt lgkmcnt(12)
    v_mfma_f32_16x16x32_bf16 v[72:75], v[24:27], v[104:107], v[72:75]
    ds_read_b64_tr_b16 v[100:101], v113 offset:28672
    ds_read_b64_tr_b16 v[102:103], v113 offset:29184
    s_waitcnt lgkmcnt(12)
    v_mfma_f32_16x16x32_bf16 v[76:79], v[24:27], v[108:111], v[76:79]
    ds_read_b64_tr_b16 v[104:105], v114 offset:28672
    ds_read_b64_tr_b16 v[106:107], v114 offset:29184
    s_waitcnt lgkmcnt(12)
    v_mfma_f32_16x16x32_bf16 v[48:51], v[28:31], v[32:35], v[48:51]
    ds_read_b64_tr_b16 v[108:109], v115 offset:28672
    ds_read_b64_tr_b16 v[110:111], v115 offset:29184
    s_waitcnt lgkmcnt(12)
    v_mfma_f32_16x16x32_bf16 v[52:55], v[28:31], v[36:39], v[52:55]
    s_waitcnt lgkmcnt(10)
    v_mfma_f32_16x16x32_bf16 v[56:59], v[28:31], v[40:43], v[56:59]
    s_waitcnt lgkmcnt(8)
    v_mfma_f32_16x16x32_bf16 v[60:63], v[28:31], v[44:47], v[60:63]
    s_waitcnt lgkmcnt(6)
    v_mfma_f32_16x16x32_bf16 v[64:67], v[28:31], v[96:99], v[64:67]
    s_waitcnt lgkmcnt(4)
    v_mfma_f32_16x16x32_bf16 v[68:71], v[28:31], v[100:103], v[68:71]
    s_waitcnt lgkmcnt(2)
    v_mfma_f32_16x16x32_bf16 v[72:75], v[28:31], v[104:107], v[72:75]
    s_waitcnt lgkmcnt(0)
    v_mfma_f32_16x16x32_bf16 v[76:79], v[28:31], v[108:111], v[76:79]
    s_add_u32 s28, s26, s56
    s_addc_u32 s29, s27, 0
    s_and_b32 s29, s29, 0xffff
    s_mov_b32 s30, s62
    s_mov_b32 s31, 0x00020000
    s_mov_b32 s58, 0xbfb8aa3b
    s_mov_b32 s59, s58
    v_lshrrev_b32 v117, 4, v1
    v_and_b32 v118, 15, v1
    v_lshlrev_b32 v118, 4, v118
    v_lshl_or_b32 v117, v117, 10, v118
    s_add_u32 s64, s61, s55
    v_pk_mul_f32 v[48:49], v[48:49], s[58:59]
    v_pk_mul_f32 v[50:51], v[50:51], s[58:59]
    v_pk_mul_f32 v[52:53], v[52:53], s[58:59]
    v_pk_mul_f32 v[54:55], v[54:55], s[58:59]
    v_pk_mul_f32 v[56:57], v[56:57], s[58:59]
    v_pk_mul_f32 v[58:59], v[58:59], s[58:59]
    v_pk_mul_f32 v[60:61], v[60:61], s[58:59]
    v_pk_mul_f32 v[62:63], v[62:63], s[58:59]
    v_cvt_pk_bf16_f32 v80, v48, v52
    v_cvt_pk_bf16_f32 v81, v56, v60
    v_cvt_pk_bf16_f32 v82, v64, v68
    v_cvt_pk_bf16_f32 v83, v72, v76
    buffer_store_dwordx4 v[80:83], v117, s[28:31], s64 offen offset:0 sc1
    v_cvt_pk_bf16_f32 v84, v49, v53
    v_cvt_pk_bf16_f32 v85, v57, v61
    v_cvt_pk_bf16_f32 v86, v65, v69
    v_cvt_pk_bf16_f32 v87, v73, v77
    buffer_store_dwordx4 v[84:87], v117, s[28:31], s64 offen offset:256 sc1
    v_cvt_pk_bf16_f32 v88, v50, v54
    v_cvt_pk_bf16_f32 v89, v58, v62
    v_cvt_pk_bf16_f32 v90, v66, v70
    v_cvt_pk_bf16_f32 v91, v74, v78
    buffer_store_dwordx4 v[88:91], v117, s[28:31], s64 offen offset:512 sc1
    v_cvt_pk_bf16_f32 v92, v51, v55
    v_cvt_pk_bf16_f32 v93, v59, v63
    v_cvt_pk_bf16_f32 v94, v67, v71
    v_cvt_pk_bf16_f32 v95, v75, v79
    buffer_store_dwordx4 v[92:95], v117, s[28:31], s64 offen offset:768 sc1
    v_mov_b32 v124, 1572
    v_mov_b32 v125, 1
    s_mov_b64 exec, 1
    ds_add_u32 v124, v125
    s_mov_b64 exec, -1
    s_setprio 1
    ds_read_b128 v[4:7], v4
    s_mov_b32 s59, 30000
F_NONCE6:
    s_cmp_lg_u32 s72, 0
    s_cbranch_scc1 F_NONCED6
    s_mov_b32 s28, s24
    s_and_b32 s29, s25, 0xffff
    s_mov_b32 s30, 8
    s_mov_b32 s31, 0x00020000
    v_mov_b32 v13, 0
    buffer_load_dwordx2 v[124:125], v13, s[28:31], 0 offen sc1
    s_waitcnt vmcnt(0)
    v_readfirstlane_b32 s72, v124
    v_readfirstlane_b32 s73, v125
    s_sub_u32 s59, s59, 1
    s_cmp_eq_u32 s59, 0
    s_cbranch_scc1 K2_END
    s_branch F_NONCE6
F_NONCED6:
    s_waitcnt vmcnt(0)
    s_mov_b64 exec, 1
    v_mov_b32 v124, 1556
    v_mov_b32 v125, 1
    ds_add_rtn_u32 v125, v124, v125
    s_waitcnt lgkmcnt(0)
    v_readfirstlane_b32 s58, v125
    s_mov_b64 exec, -1
    s_cmp_lg_u32 s58, 7
    s_cbranch_scc1 F_TPUB
    s_add_u32 s28, s26, 0x1040000
    s_addc_u32 s29, s27, 0
    s_and_b32 s29, s29, 0xffff
    s_mov_b32 s30, 32768
    s_mov_b32 s31, 0x00020000
    s_lshl_b32 s58, s53, 7
    s_or_b32 s58, s58, s54
    s_lshl_b32 s58, s58, 7
    v_mov_b32 v124, s73
    v_mov_b32 v125, s72
    v_mov_b32 v13, 0
    s_mov_b64 exec, 1
    buffer_store_dwordx2 v[124:125], v13, s[28:31], s58 offen sc1
    s_mov_b64 exec, -1
F_TPUB:
    ds_read_b64_tr_b16 v[32:33], v112 offset:32768
    ds_read_b64_tr_b16 v[34:35], v112 offset:33280
    ds_read_b64_tr_b16 v[36:37], v113 offset:32768
    ds_read_b64_tr_b16 v[38:39], v113 offset:33280
    ds_read_b64_tr_b16 v[40:41], v114 offset:32768
    ds_read_b64_tr_b16 v[42:43], v114 offset:33280
    ds_read_b64_tr_b16 v[44:45], v115 offset:32768
    ds_read_b64_tr_b16 v[46:47], v115 offset:33280
    ds_read_b64_tr_b16 v[96:97], v112 offset:49152
    ds_read_b64_tr_b16 v[98:99], v112 offset:49664
    ds_read_b64_tr_b16 v[100:101], v113 offset:49152
    ds_read_b64_tr_b16 v[102:103], v113 offset:49664
    ds_read_b64_tr_b16 v[104:105], v114 offset:49152
    ds_read_b64_tr_b16 v[106:107], v114 offset:49664
    s_waitcnt lgkmcnt(12)
    v_mfma_f32_16x16x32_bf16 v[48:51], v[16:19], v[32:35], 0
    ds_read_b64_tr_b16 v[108:109], v115 offset:49152
    ds_read_b64_tr_b16 v[110:111], v115 offset:49664
    s_waitcnt lgkmcnt(12)
    v_mfma_f32_16x16x32_bf16 v[52:55], v[16:19], v[36:39], 0
    ds_read_b64_tr_b16 v[32:33], v112 offset:36864
    ds_read_b64_tr_b16 v[34:35], v112 offset:37376
    s_waitcnt lgkmcnt(12)
    v_mfma_f32_16x16x32_bf16 v[56:59], v[16:19], v[40:43], 0
    ds_read_b64_tr_b16 v[36:37], v113 offset:36864
    ds_read_b64_tr_b16 v[38:39], v113 offset:37376
    s_waitcnt lgkmcnt(12)
    v_mfma_f32_16x16x32_bf16 v[60:63], v[16:19], v[44:47], 0
    ds_read_b64_tr_b16 v[40:41], v114 offset:36864
    ds_read_b64_tr_b16 v[42:43], v114 offset:37376
    s_waitcnt lgkmcnt(12)
    v_mfma_f32_16x16x32_bf16 v[64:67], v[96:99], v[16:19], 0
    ds_read_b64_tr_b16 v[44:45], v115 offset:36864
    ds_read_b64_tr_b16 v[46:47], v115 offset:37376
    s_waitcnt lgkmcnt(12)
    v_mfma_f32_16x16x32_bf16 v[68:71], v[100:103], v[16:19], 0
    ds_read_b64_tr_b16 v[96:97], v112 offset:53248
    ds_read_b64_tr_b16 v[98:99], v112 offset:53760
    s_waitcnt lgkmcnt(12)
    v_mfma_f32_16x16x32_bf16 v[72:75], v[104:107], v[16:19], 0
    ds_read_b64_tr_b16 v[100:101], v113 offset:53248
    ds_read_b64_tr_b16 v[102:103], v113 offset:53760
    s_waitcnt lgkmcnt(12)
    v_mfma_f32_16x16x32_bf16 v[76:79], v[108:111], v[16:19], 0
    ds_read_b64_tr_b16 v[104:105], v114 offset:53248
    ds_read_b64_tr_b16 v[106:107], v114 offset:53760
    s_waitcnt lgkmcnt(12)
    v_mfma_f32_16x16x32_bf16 v[48:51], v[20:23], v[32:35], v[48:51]
    ds_read_b64_tr_b16 v[108:109], v115 offset:53248
    ds_read_b64_tr_b16 v[110:111], v115 offset:53760
    s_waitcnt lgkmcnt(12)
    v_mfma_f32_16x16x32_bf16 v[52:55], v[20:23], v[36:39], v[52:55]
    ds_read_b64_tr_b16 v[32:33], v112 offset:40960
    ds_read_b64_tr_b16 v[34:35], v112 offset:41472
    s_waitcnt lgkmcnt(12)
    v_mfma_f32_16x16x32_bf16 v[56:59], v[20:23], v[40:43], v[56:59]
    ds_read_b64_tr_b16 v[36:37], v113 offset:40960
    ds_read_b64_tr_b16 v[38:39], v113 offset:41472
    s_waitcnt lgkmcnt(12)
    v_mfma_f32_16x16x32_bf16 v[60:63], v[20:23], v[44:47], v[60:63]
    ds_read_b64_tr_b16 v[40:41], v114 offset:40960
    ds_read_b64_tr_b16 v[42:43], v114 offset:41472
    s_waitcnt lgkmcnt(12)
    v_mfma_f32_16x16x32_bf16 v[64:67], v[96:99], v[20:23], v[64:67]
    ds_read_b64_tr_b16 v[44:45], v115 offset:40960
    ds_read_b64_tr_b16 v[46:47], v115 offset:41472
    s_waitcnt lgkmcnt(12)
    v_mfma_f32_16x16x32_bf16 v[68:71], v[100:103], v[20:23], v[68:71]
    ds_read_b64_tr_b16 v[96:97], v112 offset:57344
    ds_read_b64_tr_b16 v[98:99], v112 offset:57856
    s_waitcnt lgkmcnt(12)
    v_mfma_f32_16x16x32_bf16 v[72:75], v[104:107], v[20:23], v[72:75]
    ds_read_b64_tr_b16 v[100:101], v113 offset:57344
    ds_read_b64_tr_b16 v[102:103], v113 offset:57856
    s_waitcnt lgkmcnt(12)
    v_mfma_f32_16x16x32_bf16 v[76:79], v[108:111], v[20:23], v[76:79]
    ds_read_b64_tr_b16 v[104:105], v114 offset:57344
    ds_read_b64_tr_b16 v[106:107], v114 offset:57856
    s_waitcnt lgkmcnt(12)
    v_mfma_f32_16x16x32_bf16 v[48:51], v[24:27], v[32:35], v[48:51]
    ds_read_b64_tr_b16 v[108:109], v115 offset:57344
    ds_read_b64_tr_b16 v[110:111], v115 offset:57856
    s_waitcnt lgkmcnt(12)
    v_mfma_f32_16x16x32_bf16 v[52:55], v[24:27], v[36:39], v[52:55]
    ds_read_b64_tr_b16 v[32:33], v112 offset:45056
    ds_read_b64_tr_b16 v[34:35], v112 offset:45568
    s_waitcnt lgkmcnt(12)
    v_mfma_f32_16x16x32_bf16 v[56:59], v[24:27], v[40:43], v[56:59]
    ds_read_b64_tr_b16 v[36:37], v113 offset:45056
    ds_read_b64_tr_b16 v[38:39], v113 offset:45568
    s_waitcnt lgkmcnt(12)
    v_mfma_f32_16x16x32_bf16 v[60:63], v[24:27], v[44:47], v[60:63]
    ds_read_b64_tr_b16 v[40:41], v114 offset:45056
    ds_read_b64_tr_b16 v[42:43], v114 offset:45568
    s_waitcnt lgkmcnt(12)
    v_mfma_f32_16x16x32_bf16 v[64:67], v[96:99], v[24:27], v[64:67]
    ds_read_b64_tr_b16 v[44:45], v115 offset:45056
    ds_read_b64_tr_b16 v[46:47], v115 offset:45568
    s_waitcnt lgkmcnt(12)
    v_mfma_f32_16x16x32_bf16 v[68:71], v[100:103], v[24:27], v[68:71]
    ds_read_b64_tr_b16 v[96:97], v112 offset:61440
    ds_read_b64_tr_b16 v[98:99], v112 offset:61952
    s_waitcnt lgkmcnt(12)
    v_mfma_f32_16x16x32_bf16 v[72:75], v[104:107], v[24:27], v[72:75]
    ds_read_b64_tr_b16 v[100:101], v113 offset:61440
    ds_read_b64_tr_b16 v[102:103], v113 offset:61952
    s_waitcnt lgkmcnt(12)
    v_mfma_f32_16x16x32_bf16 v[76:79], v[108:111], v[24:27], v[76:79]
    ds_read_b64_tr_b16 v[104:105], v114 offset:61440
    ds_read_b64_tr_b16 v[106:107], v114 offset:61952
    s_waitcnt lgkmcnt(12)
    v_mfma_f32_16x16x32_bf16 v[48:51], v[28:31], v[32:35], v[48:51]
    ds_read_b64_tr_b16 v[108:109], v115 offset:61440
    ds_read_b64_tr_b16 v[110:111], v115 offset:61952
    s_waitcnt lgkmcnt(12)
    v_mfma_f32_16x16x32_bf16 v[52:55], v[28:31], v[36:39], v[52:55]
    s_waitcnt lgkmcnt(10)
    v_mfma_f32_16x16x32_bf16 v[56:59], v[28:31], v[40:43], v[56:59]
    s_waitcnt lgkmcnt(8)
    v_mfma_f32_16x16x32_bf16 v[60:63], v[28:31], v[44:47], v[60:63]
    s_waitcnt lgkmcnt(6)
    v_mfma_f32_16x16x32_bf16 v[64:67], v[96:99], v[28:31], v[64:67]
    s_waitcnt lgkmcnt(4)
    v_mfma_f32_16x16x32_bf16 v[68:71], v[100:103], v[28:31], v[68:71]
    s_waitcnt lgkmcnt(2)
    v_mfma_f32_16x16x32_bf16 v[72:75], v[104:107], v[28:31], v[72:75]
    s_waitcnt lgkmcnt(0)
    v_mfma_f32_16x16x32_bf16 v[76:79], v[108:111], v[28:31], v[76:79]
    s_cmp_eq_u32 s60, 6
    s_cselect_b32 s70, 0, -1
    v_lshrrev_b32 v117, 4, v1
    v_and_b32 v118, 15, v1
    v_lshlrev_b32 v112, 4, v118
    v_lshl_or_b32 v112, v117, 10, v112
    v_add_u32 v112, s61, v112
    v_mul_u32_u24 v118, 144, v118
    v_lshl_add_u32 v117, v117, 3, v118
    s_mul_i32 s58, s60, 2304
    s_add_u32 s58, s58, 78848
    v_add_u32 v117, s58, v117
    s_mov_b32 s58, 0xbfb8aa3b
    v_mov_b32 v118, 0xc2200000
    s_or_b32 s68, s70, 0xffff
    s_mov_b32 s69, s70
    s_mov_b64 exec, s[68:69]
    v_fma_f32 v16, v48, s58, v118
    v_fma_f32 v17, v52, s58, v118
    v_fma_f32 v18, v56, s58, v118
    v_fma_f32 v19, v60, s58, v118
    ds_write_b128 v112, v[16:19] offset:53248
    v_fma_f32 v20, v49, s58, v118
    v_fma_f32 v21, v53, s58, v118
    v_fma_f32 v22, v57, s58, v118
    v_fma_f32 v23, v61, s58, v118
    ds_write_b128 v112, v[20:23] offset:53504
    v_fma_f32 v24, v50, s58, v118
    v_fma_f32 v25, v54, s58, v118
    v_fma_f32 v26, v58, s58, v118
    v_fma_f32 v27, v62, s58, v118
    ds_write_b128 v112, v[24:27] offset:53760
    v_fma_f32 v28, v51, s58, v118
    v_fma_f32 v29, v55, s58, v118
    v_fma_f32 v30, v59, s58, v118
    v_fma_f32 v31, v63, s58, v118
    ds_write_b128 v112, v[28:31] offset:54016
    s_or_b32 s68, s70, 0x000f000f
    s_mov_b32 s69, s68
    s_mov_b64 exec, s[68:69]
    v_cvt_pk_bf16_f32 v32, v64, v65
    v_cvt_pk_bf16_f32 v33, v66, v67
    ds_write_b64 v117, v[32:33] offset:0
    v_cvt_pk_bf16_f32 v34, v68, v69
    v_cvt_pk_bf16_f32 v35, v70, v71
    ds_write_b64 v117, v[34:35] offset:32
    v_cvt_pk_bf16_f32 v36, v72, v73
    v_cvt_pk_bf16_f32 v37, v74, v75
    ds_write_b64 v117, v[36:37] offset:64
    v_cvt_pk_bf16_f32 v38, v76, v77
    v_cvt_pk_bf16_f32 v39, v78, v79
    ds_write_b64 v117, v[38:39] offset:96
    s_mov_b64 exec, -1
    s_branch F_COMMON
F_NOTABLE:
    ds_read_b128 v[4:7], v4
    s_cmp_lg_u32 s54, 0
    s_cbranch_scc1 F_TDONE
    s_add_u32 s28, s26, s56
    s_addc_u32 s29, s27, 0
    s_and_b32 s29, s29, 0xffff
    s_mov_b32 s30, 3200256
    s_mov_b32 s31, 0x00020000
    s_mov_b32 s58, 3200000
    v_mov_b32 v48, 0x70007000
    v_mov_b32 v49, 0x70007000
    v_mov_b64 v[50:51], 0
    v_lshlrev_b32 v117, 4, v1
    s_mov_b64 exec, 0xffff
    buffer_store_dwordx4 v[48:51], v117, s[28:31], s58 offen sc1
    s_mov_b64 exec, -1
F_TDONE:
    s_mov_b32 s59, 30000
F_NONCE7:
    s_cmp_lg_u32 s72, 0
    s_cbranch_scc1 F_NONCED7
    s_mov_b32 s28, s24
    s_and_b32 s29, s25, 0xffff
    s_mov_b32 s30, 8
    s_mov_b32 s31, 0x00020000
    v_mov_b32 v13, 0
    buffer_load_dwordx2 v[124:125], v13, s[28:31], 0 offen sc1
    s_waitcnt vmcnt(0)
    v_readfirstlane_b32 s72, v124
    v_readfirstlane_b32 s73, v125
    s_sub_u32 s59, s59, 1
    s_cmp_eq_u32 s59, 0
    s_cbranch_scc1 K2_END
    s_branch F_NONCE7
F_NONCED7:
    s_waitcnt vmcnt(0)
    s_mov_b64 exec, 1
    v_mov_b32 v124, 1556
    v_mov_b32 v125, 1
    ds_add_rtn_u32 v125, v124, v125
    s_waitcnt lgkmcnt(0)
    v_readfirstlane_b32 s58, v125
    s_mov_b64 exec, -1
    s_cmp_lg_u32 s58, 7
    s_cbranch_scc1 F_COMMON
    s_add_u32 s28, s26, 0x1040000
    s_addc_u32 s29, s27, 0
    s_and_b32 s29, s29, 0xffff
    s_mov_b32 s30, 32768
    s_mov_b32 s31, 0x00020000
    s_lshl_b32 s58, s53, 7
    s_or_b32 s58, s58, s54
    s_lshl_b32 s58, s58, 7
    v_mov_b32 v124, s73
    v_mov_b32 v125, s72
    v_mov_b32 v13, 0
    s_mov_b64 exec, 1
    buffer_store_dwordx2 v[124:125], v13, s[28:31], s58 offen sc1
    s_mov_b64 exec, -1
F_COMMON:
    s_add_u32 s44, s26, 0x800000
    s_addc_u32 s45, s27, 0
    s_and_b32 s45, s45, 0xffff
    s_mov_b32 s46, 4800000
    s_mov_b32 s47, 0x00020000
    s_mov_b32 s60, 0
    v_mov_b32 v2, 0
    v_mov_b32 v3, 0
    v_mov_b32 v126, 0
    v_mov_b32 v127, 0
    s_cmp_ge_u32 s52, 8
    s_cbranch_scc1 F_POLLED
    s_add_u32 s28, s26, 0x1000000
    s_addc_u32 s29, s27, 0
    s_and_b32 s29, s29, 0xffff
    s_mov_b32 s30, 256000
    s_mov_b32 s31, 0x00020000
    v_lshrrev_b32 v2, 2, v0
    v_lshlrev_b32 v13, 10, v2
    s_movk_i32 s58, 122
    v_cmp_gt_u32 s[70:71], s58, v2
    v_and_b32 v115, 3, v0
    v_mul_u32_u24 v2, 19200, v2
    v_mad_u32_u24 v2, v115, 12, v2
    v_add_u32 v126, 2457600, v2
    v_mov_b32 v118, 0
    s_lshl_b32 s58, s54, 3
    s_add_u32 s61, s58, 131072
    s_mov_b32 s59, 30000
    s_mov_b64 vcc, -1
F_POLL:
    s_mov_b64 exec, vcc
    buffer_load_dwordx2 v[116:117], v13, s[28:31], s58 offen sc1
    s_mov_b64 exec, s[70:71]
    buffer_load_dwordx2 v[118:119], v13, s[28:31], s61 offen sc1
    s_sub_u32 s59, s59, 1
    s_cmp_eq_u32 s59, 0
    s_cbranch_scc1 K2_END
    s_waitcnt vmcnt(0)
    v_and_b32 v127, 0xffc00000, v118
    v_cmp_ne_u32 s[70:71], s72, v119
    v_cmp_ne_u32 s[68:69], s73, v127
    s_mov_b64 exec, vcc
    s_or_b64 s[70:71], s[70:71], s[68:69]
    v_and_b32 v3, 0xffc00000, v116
    v_cmp_ne_u32 vcc, s72, v117
    v_cmp_ne_u32 s[68:69], s73, v3
    s_or_b64 vcc, vcc, s[68:69]
    s_or_b64 s[68:69], vcc, s[70:71]
    s_cbranch_scc0 F_POLLOK
    s_sleep 4
    s_branch F_POLL
F_POLLOK:
    s_setprio 0
    s_mov_b64 exec, -1
    v_and_b32 v13, 0x7ff, v116
    v_bfe_u32 v3, v116, 11, 11
    v_mad_u32_u24 v2, v13, 12, v2
    v_sub_u32 v3, v3, v115
    v_and_b32 v13, 0x7ff, v118
    v_bfe_u32 v127, v118, 11, 11
    v_mad_u32_u24 v126, v13, 12, v126
    v_sub_u32 v127, v127, v115
F_POLLED:
K2_ROUND:
    s_cmp_ge_u32 s52, 8
    s_cbranch_scc1 F_LOADED
    v_cmpx_lt_i32 vcc, 0, v3
    buffer_load_dwordx3 v[18:20], v2, s[44:47], 0 offen offset:0 sc1
    v_cmpx_lt_i32 vcc, 4, v3
    buffer_load_dwordx3 v[24:26], v2, s[44:47], 0 offen offset:48 sc1
    v_cmpx_lt_i32 vcc, 8, v3
    buffer_load_dwordx3 v[30:32], v2, s[44:47], 0 offen offset:96 sc1
    v_cmpx_lt_i32 vcc, 12, v3
    buffer_load_dwordx3 v[36:38], v2, s[44:47], 0 offen offset:144 sc1
    v_cmpx_lt_i32 vcc, 16, v3
    buffer_load_dwordx3 v[92:94], v2, s[44:47], 0 offen offset:192 sc1
    v_cmpx_lt_i32 vcc, 20, v3
    buffer_load_dwordx3 v[96:98], v2, s[44:47], 0 offen offset:240 sc1
    v_cmpx_lt_i32 vcc, 24, v3
    buffer_load_dwordx3 v[100:102], v2, s[44:47], 0 offen offset:288 sc1
    v_cmpx_lt_i32 vcc, 28, v3
    buffer_load_dwordx3 v[104:106], v2, s[44:47], 0 offen offset:336 sc1
    v_cmpx_lt_i32 vcc, 32, v3
    buffer_load_dwordx3 v[108:110], v2, s[44:47], 0 offen offset:384 sc1
    s_mov_b64 exec, -1
    v_cmpx_lt_i32 vcc, 0, v127
    buffer_load_dwordx3 v[40:42], v126, s[44:47], 0 offen offset:0 sc1
    v_cmpx_lt_i32 vcc, 4, v127
    buffer_load_dwordx3 v[44:46], v126, s[44:47], 0 offen offset:48 sc1
    v_cmpx_lt_i32 vcc, 8, v127
    buffer_load_dwordx3 v[48:50], v126, s[44:47], 0 offen offset:96 sc1
    v_cmpx_lt_i32 vcc, 12, v127
    buffer_load_dwordx3 v[52:54], v126, s[44:47], 0 offen offset:144 sc1
    v_cmpx_lt_i32 vcc, 16, v127
    buffer_load_dwordx3 v[56:58], v126, s[44:47], 0 offen offset:192 sc1
    v_cmpx_lt_i32 vcc, 20, v127
    buffer_load_dwordx3 v[60:62], v126, s[44:47], 0 offen offset:240 sc1
    v_cmpx_lt_i32 vcc, 24, v127
    buffer_load_dwordx3 v[64:66], v126, s[44:47], 0 offen offset:288 sc1
    v_cmpx_lt_i32 vcc, 28, v127
    buffer_load_dwordx3 v[68:70], v126, s[44:47], 0 offen offset:336 sc1
    v_cmpx_lt_i32 vcc, 32, v127
    buffer_load_dwordx3 v[84:86], v126, s[44:47], 0 offen offset:384 sc1
    s_mov_b64 exec, -1
F_LOADED:
    s_cmp_lg_u32 s60, 0
    s_cbranch_scc1 F_SETUPDONE
    s_mov_b32 s48, s22
    s_and_b32 s49, s23, 0xffff
    s_mov_b32 s50, 3200000
    s_mov_b32 s51, 0x00020000
    s_add_u32 s40, s26, s56
    s_addc_u32 s41, s27, 0
    s_and_b32 s41, s41, 0xffff
    s_or_b32 s41, s41, 0x1000000
    s_mov_b32 s42, 3200256
    s_mov_b32 s43, 0x00020000
    v_lshlrev_b32 v13, 3, v1
    ds_read_b64 v[16:17], v13 offset:50688
    ds_read_b64 v[22:23], v13 offset:50688
    ds_read_b64 v[28:29], v13 offset:50688
    ds_read_b64 v[34:35], v13 offset:50688
    v_and_b32 v13, 15, v1
    v_lshlrev_b32 v81, 4, v13
    v_mov_b32 v83, v81
    v_mul_u32_u24 v11, 12, v13
    v_and_b32 v13, 1, v1
    v_lshlrev_b32 v13, 4, v13
    s_movk_i32 s58, 0x3f80
    v_lshlrev_b32 v13, v13, s58
    v_and_b32 v115, 2, v1
    v_cmp_eq_u32 vcc, 0, v115
    v_lshrrev_b32 v113, 4, v1
    v_bfe_u32 v114, v1, 2, 2
    v_cndmask_b32 v14, 0, v13, vcc
    v_cndmask_b32 v15, v13, 0, vcc
    v_cmp_eq_u32 vcc, v113, v114
    v_and_b32 v13, 3, v1
    v_cmp_eq_u32 s[74:75], v113, v13
    v_cndmask_b32 v74, 0, v14, vcc
    v_cndmask_b32 v75, 0, v15, vcc
    v_mov_b32 v13, 0x80
    v_mov_b64 v[78:79], v[74:75]
    v_cndmask_b32 v12, 0, v13, s[74:75]
    v_mov_b32 v10, 1792
    s_mov_b32 s66, 0x2b800000
    s_mov_b32 s67, s66
F_SETUPDONE:
    s_mov_b32 s61, 36
    v_mov_b32 v89, 1
K2_RANK:
    s_cmp_ge_u32 s52, 8
    s_cbranch_scc1 K2_RANKED1
    s_sub_u32 s58, s61, 3
    v_max_i32 v13, v3, v127
    v_min_i32 v125, s58, v3
    v_min_i32 v88, s58, v127
    v_cmpx_lt_i32 vcc, s61, v13
    s_cbranch_execz K2_NOFLAG
    v_mov_b32 v13, 1536
    ds_write_b32 v13, v89
K2_NOFLAG:
    s_mov_b64 exec, -1
    v_cmpx_lt_i32 vcc, 0, v125
    s_waitcnt vmcnt(17)
    v_lshrrev_b32 v116, 22, v20
    ds_add_rtn_u32 v21, v116, v89 offset:1024
    v_cmpx_lt_i32 vcc, 4, v125
    s_waitcnt vmcnt(16)
    v_lshrrev_b32 v117, 22, v26
    ds_add_rtn_u32 v27, v117, v89 offset:1024
    v_cmpx_lt_i32 vcc, 8, v125
    s_waitcnt vmcnt(15)
    v_lshrrev_b32 v118, 22, v32
    ds_add_rtn_u32 v33, v118, v89 offset:1024
    v_cmpx_lt_i32 vcc, 12, v125
    s_waitcnt vmcnt(14)
    v_lshrrev_b32 v119, 22, v38
    ds_add_rtn_u32 v39, v119, v89 offset:1024
    v_cmpx_lt_i32 vcc, 16, v125
    s_cbranch_execz K2_RANKED0
    s_waitcnt vmcnt(13)
    v_lshrrev_b32 v120, 22, v94
    ds_add_rtn_u32 v95, v120, v89 offset:1024
    v_cmpx_lt_i32 vcc, 20, v125
    s_cbranch_execz K2_RANKED0
    s_waitcnt vmcnt(12)
    v_lshrrev_b32 v121, 22, v98
    ds_add_rtn_u32 v99, v121, v89 offset:1024
    v_cmpx_lt_i32 vcc, 24, v125
    s_cbranch_execz K2_RANKED0
    s_waitcnt vmcnt(11)
    v_lshrrev_b32 v122, 22, v102
    ds_add_rtn_u32 v103, v122, v89 offset:1024
    v_cmpx_lt_i32 vcc, 28, v125
    s_cbranch_execz K2_RANKED0
    s_waitcnt vmcnt(10)
    v_lshrrev_b32 v123, 22, v106
    ds_add_rtn_u32 v107, v123, v89 offset:1024
    v_cmpx_lt_i32 vcc, 32, v125
    s_cbranch_execz K2_RANKED0
    s_waitcnt vmcnt(9)
    v_lshrrev_b32 v124, 22, v110
    ds_add_rtn_u32 v111, v124, v89 offset:1024
K2_RANKED0:
    s_mov_b64 exec, -1
    v_cmpx_lt_i32 vcc, 0, v88
    s_waitcnt vmcnt(8)
    v_lshrrev_b32 v112, 22, v42
    ds_add_rtn_u32 v43, v112, v89 offset:1024
    v_cmpx_lt_i32 vcc, 4, v88
    s_waitcnt vmcnt(7)
    v_lshrrev_b32 v112, 22, v46
    ds_add_rtn_u32 v47, v112, v89 offset:1024
    v_cmpx_lt_i32 vcc, 8, v88
    s_waitcnt vmcnt(6)
    v_lshrrev_b32 v112, 22, v50
    ds_add_rtn_u32 v51, v112, v89 offset:1024
    v_cmpx_lt_i32 vcc, 12, v88
    s_waitcnt vmcnt(5)
    v_lshrrev_b32 v112, 22, v54
    ds_add_rtn_u32 v55, v112, v89 offset:1024
    v_cmpx_lt_i32 vcc, 16, v88
    s_cbranch_execz K2_RANKED1
    s_waitcnt vmcnt(4)
    v_lshrrev_b32 v112, 22, v58
    ds_add_rtn_u32 v59, v112, v89 offset:1024
    v_cmpx_lt_i32 vcc, 20, v88
    s_cbranch_execz K2_RANKED1
    s_waitcnt vmcnt(3)
    v_lshrrev_b32 v112, 22, v62
    ds_add_rtn_u32 v63, v112, v89 offset:1024
    v_cmpx_lt_i32 vcc, 24, v88
    s_cbranch_execz K2_RANKED1
    s_waitcnt vmcnt(2)
    v_lshrrev_b32 v112, 22, v66
    ds_add_rtn_u32 v67, v112, v89 offset:1024
    v_cmpx_lt_i32 vcc, 28, v88
    s_cbranch_execz K2_RANKED1
    s_waitcnt vmcnt(1)
    v_lshrrev_b32 v112, 22, v70
    ds_add_rtn_u32 v71, v112, v89 offset:1024
    v_cmpx_lt_i32 vcc, 32, v88
    s_cbranch_execz K2_RANKED1
    s_waitcnt vmcnt(0)
    v_lshrrev_b32 v112, 22, v86
    ds_add_rtn_u32 v87, v112, v89 offset:1024
K2_RANKED1:
    s_mov_b64 exec, -1
    v_lshlrev_b32 v13, 3, v1
    v_mov_b32 v113, 1536
    s_waitcnt lgkmcnt(0)
    s_barrier
    ds_read_b64 v[90:91], v13 offset:1024
    ds_read_b32 v82, v113
    s_cmp_lg_u32 s52, 15
    s_cbranch_scc1 K2_NOPFB
    s_lshl_b32 s58, s53, 14
    s_add_u32 s58, s58, 17039360
    s_add_u32 s28, s26, s58
    s_addc_u32 s29, s27, 0
    s_and_b32 s29, s29, 0xffff
    s_mov_b32 s30, 16384
    s_mov_b32 s31, 0x00020000
    v_lshlrev_b32 v112, 7, v1
    s_mov_b32 s59, 30000
    s_movk_i32 s58, 0x2000
    s_mov_b64 vcc, -1
F_TPOLL:
    s_mov_b64 exec, vcc
    buffer_load_dwordx2 v[120:121], v112, s[28:31], 0 offen sc1
    buffer_load_dwordx2 v[122:123], v112, s[28:31], s58 offen sc1
    s_sub_u32 s59, s59, 1
    s_cmp_eq_u32 s59, 0
    s_cbranch_scc1 K2_END
    s_waitcnt vmcnt(0)
    v_cmp_ne_u32 vcc, s73, v120
    v_cmp_ne_u32 s[68:69], s72, v121
    s_or_b64 vcc, vcc, s[68:69]
    v_cmp_ne_u32 s[70:71], s73, v122
    v_cmp_ne_u32 s[68:69], s72, v123
    s_or_b64 vcc, vcc, s[70:71]
    s_or_b64 vcc, vcc, s[68:69]
    s_cbranch_vccz F_TPOLLOK
    s_sleep 4
    s_branch F_TPOLL
F_TPOLLOK:
    s_mov_b64 exec, -1
    s_lshr_b32 s58, s2, 3
    s_mul_i32 s58, s58, 100096
    s_add_u32 s58, s58, s56
    s_add_u32 s76, s26, s58
    s_addc_u32 s77, s27, 0
    s_and_b32 s77, s77, 0xffff
    s_mov_b32 s78, 100096
    s_mov_b32 s79, 0x00020000
    s_mov_b32 s58, 0
    buffer_load_dword v44, v112, s[76:79], s58 offen sc1
    s_mov_b32 s58, 8192
    buffer_load_dword v44, v112, s[76:79], s58 offen sc1
    s_mov_b32 s58, 16384
    buffer_load_dword v44, v112, s[76:79], s58 offen sc1
    s_mov_b32 s58, 24576
    buffer_load_dword v44, v112, s[76:79], s58 offen sc1
K2_NOPFB:
    s_waitcnt lgkmcnt(1)
    v_add_u32 v72, 1, v90
    v_add_u32 v73, 1, v91
    v_lshrrev_b32 v72, 1, v72
    v_lshrrev_b32 v73, 1, v73
    v_add_u32 v80, v72, v73
    s_nop 1
    v_add_u32_dpp v80, v80, v80 row_shr:1 row_mask:0xf bank_mask:0xf bound_ctrl:0
    s_nop 1
    v_add_u32_dpp v80, v80, v80 row_shr:2 row_mask:0xf bank_mask:0xf bound_ctrl:0
    s_nop 1
    v_add_u32_dpp v80, v80, v80 row_shr:4 row_mask:0xf bank_mask:0xf bound_ctrl:0
    s_nop 1
    v_add_u32_dpp v80, v80, v80 row_shr:8 row_mask:0xf bank_mask:0xf bound_ctrl:0
    s_nop 1
    v_add_u32_dpp v80, v80, v80 row_bcast:15 row_mask:0xa bank_mask:0xf
    s_nop 1
    v_add_u32_dpp v80, v80, v80 row_bcast:31 row_mask:0xc bank_mask:0xf
    s_mov_b32 s58, 93440
    v_sub_u32 v77, v80, v73
    v_readlane_b32 s62, v80, 63
    v_sub_u32 v76, v77, v72
    v_lshl_add_u32 v77, v77, 5, s58
    v_lshl_add_u32 v76, v76, 5, s58
    s_cmp_le_u32 s62, 2112
    s_cbranch_scc0 K2_TOOMANY
    s_add_u32 s64, s62, 63
    s_lshr_b32 s64, s64, 6
    s_max_u32 s64, s64, 16
    s_cmp_ge_u32 s52, 8
    s_cbranch_scc1 K2_DUMMIES
    ds_write_b64 v13, v[76:77] offset:2048
    v_cmpx_lt_i32 vcc, 0, v125
    ds_read_b32 v116, v116 offset:2048
    v_cmpx_lt_i32 vcc, 4, v125
    ds_read_b32 v117, v117 offset:2048
    v_cmpx_lt_i32 vcc, 8, v125
    ds_read_b32 v118, v118 offset:2048
    v_cmpx_lt_i32 vcc, 12, v125
    ds_read_b32 v119, v119 offset:2048
    v_cmpx_lt_i32 vcc, 16, v125
    s_cbranch_execz K2_STARTED0
    ds_read_b32 v120, v120 offset:2048
    v_cmpx_lt_i32 vcc, 20, v125
    s_cbranch_execz K2_STARTED0
    ds_read_b32 v121, v121 offset:2048
    v_cmpx_lt_i32 vcc, 24, v125
    s_cbranch_execz K2_STARTED0
    ds_read_b32 v122, v122 offset:2048
    v_cmpx_lt_i32 vcc, 28, v125
    s_cbranch_execz K2_STARTED0
    ds_read_b32 v123, v123 offset:2048
    v_cmpx_lt_i32 vcc, 32, v125
    s_cbranch_execz K2_STARTED0
    ds_read_b32 v124, v124 offset:2048
K2_STARTED0:
    s_mov_b64 exec, -1
    v_cmpx_lt_i32 vcc, 0, v88
    v_lshrrev_b32 v112, 22, v42
    ds_read_b32 v112, v112 offset:2048
    v_cmpx_lt_i32 vcc, 4, v88
    v_lshrrev_b32 v113, 22, v46
    ds_read_b32 v113, v113 offset:2048
    v_cmpx_lt_i32 vcc, 8, v88
    v_lshrrev_b32 v114, 22, v50
    ds_read_b32 v114, v114 offset:2048
    v_cmpx_lt_i32 vcc, 12, v88
    v_lshrrev_b32 v115, 22, v54
    ds_read_b32 v115, v115 offset:2048
    v_cmpx_lt_i32 vcc, 16, v88
    s_cbranch_execz K2_STARTED1
    v_lshrrev_b32 v72, 22, v58
    ds_read_b32 v72, v72 offset:2048
    v_cmpx_lt_i32 vcc, 20, v88
    s_cbranch_execz K2_STARTED1
    v_lshrrev_b32 v73, 22, v62
    ds_read_b32 v73, v73 offset:2048
    v_cmpx_lt_i32 vcc, 24, v88
    s_cbranch_execz K2_STARTED1
    v_lshrrev_b32 v80, 22, v66
    ds_read_b32 v80, v80 offset:2048
    v_cmpx_lt_i32 vcc, 28, v88
    s_cbranch_execz K2_STARTED1
    v_lshrrev_b32 v90, 22, v70
    ds_read_b32 v90, v90 offset:2048
    v_cmpx_lt_i32 vcc, 32, v88
    s_cbranch_execz K2_STARTED1
    v_lshrrev_b32 v91, 22, v86
    ds_read_b32 v91, v91 offset:2048
K2_STARTED1:
    s_mov_b64 exec, -1
    s_waitcnt lgkmcnt(0)
    v_cmpx_lt_i32 vcc, 0, v125
    v_lshl_add_u32 v116, v21, 4, v116
    ds_write_b96 v116, v[18:20]
    v_cmpx_lt_i32 vcc, 4, v125
    v_lshl_add_u32 v117, v27, 4, v117
    ds_write_b96 v117, v[24:26]
    v_cmpx_lt_i32 vcc, 8, v125
    v_lshl_add_u32 v118, v33, 4, v118
    ds_write_b96 v118, v[30:32]
    v_cmpx_lt_i32 vcc, 12, v125
    v_lshl_add_u32 v119, v39, 4, v119
    ds_write_b96 v119, v[36:38]
    v_cmpx_lt_i32 vcc, 16, v125
    s_cbranch_execz K2_SCATTERED0
    v_lshl_add_u32 v120, v95, 4, v120
    ds_write_b96 v120, v[92:94]
    v_cmpx_lt_i32 vcc, 20, v125
    s_cbranch_execz K2_SCATTERED0
    v_lshl_add_u32 v121, v99, 4, v121
    ds_write_b96 v121, v[96:98]
    v_cmpx_lt_i32 vcc, 24, v125
    s_cbranch_execz K2_SCATTERED0
    v_lshl_add_u32 v122, v103, 4, v122
    ds_write_b96 v122, v[100:102]
    v_cmpx_lt_i32 vcc, 28, v125
    s_cbranch_execz K2_SCATTERED0
    v_lshl_add_u32 v123, v107, 4, v123
    ds_write_b96 v123, v[104:106]
    v_cmpx_lt_i32 vcc, 32, v125
    s_cbranch_execz K2_SCATTERED0
    v_lshl_add_u32 v124, v111, 4, v124
    ds_write_b96 v124, v[108:110]
K2_SCATTERED0:
    s_mov_b64 exec, -1
    v_cmpx_lt_i32 vcc, 0, v88
    v_lshl_add_u32 v112, v43, 4, v112
    ds_write_b96 v112, v[40:42]
    v_cmpx_lt_i32 vcc, 4, v88
    v_lshl_add_u32 v113, v47, 4, v113
    ds_write_b96 v113, v[44:46]
    v_cmpx_lt_i32 vcc, 8, v88
    v_lshl_add_u32 v114, v51, 4, v114
    ds_write_b96 v114, v[48:50]
    v_cmpx_lt_i32 vcc, 12, v88
    v_lshl_add_u32 v115, v55, 4, v115
    ds_write_b96 v115, v[52:54]
    v_cmpx_lt_i32 vcc, 16, v88
    s_cbranch_execz K2_SCATTERED1
    v_lshl_add_u32 v72, v59, 4, v72
    ds_write_b96 v72, v[56:58]
    v_cmpx_lt_i32 vcc, 20, v88
    s_cbranch_execz K2_SCATTERED1
    v_lshl_add_u32 v73, v63, 4, v73
    ds_write_b96 v73, v[60:62]
    v_cmpx_lt_i32 vcc, 24, v88
    s_cbranch_execz K2_SCATTERED1
    v_lshl_add_u32 v80, v67, 4, v80
    ds_write_b96 v80, v[64:66]
    v_cmpx_lt_i32 vcc, 28, v88
    s_cbranch_execz K2_SCATTERED1
    v_lshl_add_u32 v90, v71, 4, v90
    ds_write_b96 v90, v[68:70]
    v_cmpx_lt_i32 vcc, 32, v88
    s_cbranch_execz K2_SCATTERED1
    v_lshl_add_u32 v91, v87, 4, v91
    ds_write_b96 v91, v[84:86]
K2_SCATTERED1:
    s_mov_b64 exec, -1
    s_branch K2_NODUMMY
K2_DUMMIES:
    v_mov_b64 v[40:41], 0
    v_mov_b32 v42, 1644179668
    s_lshl_b32 s58, s64, 6
    s_add_u32 s58, s58, 4
    s_sub_u32 s58, s58, s62
    s_lshl_b32 s58, s58, 1
    s_add_u32 s58, s58, 512
    s_lshl_b32 s59, s62, 5
    s_add_u32 s59, s59, 85248
    v_add_u32 v46, s59, v8
    v_sub_u32 v47, s58, v0
K2_FILL:
    v_cmpx_lt_i32 vcc, 0, v47
    s_cbranch_execz K2_FILLED
    ds_write_b96 v46, v[40:42]
    v_subrev_u32 v47, 0x200, v47
    v_add_u32 v46, 0x2000, v46
    s_branch K2_FILL
K2_FILLED:
    s_mov_b64 exec, -1
    s_cmp_lg_u32 s52, 14
    s_cbranch_scc1 K2_NODUMMY
    v_lshlrev_b32 v42, 25, v1
    v_or_b32 v42, 12500, v42
    v_lshl_add_u32 v46, v90, 4, v76
    v_and_b32 v47, 1, v90
    v_cmpx_eq_u32 vcc, 1, v47
    ds_write_b96 v46, v[40:42]
    s_mov_b64 exec, -1
    s_nop 0
    v_lshlrev_b32 v42, 25, v1
    v_or_b32 v42, 16789716, v42
    v_lshl_add_u32 v46, v91, 4, v77
    v_and_b32 v47, 1, v91
    v_cmpx_eq_u32 vcc, 1, v47
    ds_write_b96 v46, v[40:42]
    s_mov_b64 exec, -1
    s_nop 0
K2_NODUMMY:
    s_lshl_b32 s58, s64, 5
    s_lshl_b32 s59, s52, 2
    s_mul_i32 s59, s59, s58
    s_add_u32 s59, s59, 93440
    v_lshrrev_b32 v113, 4, v1
    v_bfe_u32 v114, v1, 2, 2
    v_mov_b32 v13, s59
    v_mad_u32_u24 v113, v113, s58, v13
    v_mad_u32_u24 v114, v114, s58, v13
    v_lshrrev_b32 v13, 2, v81
    v_cndmask_b32 v114, v10, v114, s[74:75]
    s_waitcnt lgkmcnt(0)
    v_readfirstlane_b32 s63, v82
    s_waitcnt lgkmcnt(0)
    s_barrier
    ds_read_u16 v80, v113 offset:8
    ds_read_u16 v82, v113 offset:24
    ds_read_u16 v88, v113 offset:10
    ds_read_u16 v89, v113 offset:42
    v_mov_b64 v[104:105], 0
    v_mov_b64 v[106:107], 0
    v_mov_b64 v[108:109], 0
    v_mov_b64 v[110:111], 0
    s_waitcnt lgkmcnt(2)
    buffer_load_dwordx4 v[18:21], v[80:81], s[40:43], 0 idxen offen sc1
    buffer_load_dwordx4 v[24:27], v[82:83], s[40:43], 0 idxen offen sc1
    ds_read_u16 v80, v113 offset:40
    ds_read_u16 v82, v113 offset:56
    s_waitcnt lgkmcnt(2)
    v_add_u32 v88, v88, v81
    v_add_u32 v89, v89, v81
    s_waitcnt lgkmcnt(0)
    buffer_load_dwordx4 v[30:33], v[80:81], s[40:43], 0 idxen offen sc1
    buffer_load_dwordx4 v[36:39], v[82:83], s[40:43], 0 idxen offen sc1
    ds_read_b128 v[84:87], v88 offset:53248
    ds_read_b64 v[72:73], v114 offset:0
    ds_read_b64 v[76:77], v114 offset:16
    ds_read_u16 v80, v113 offset:72
    ds_read_u16 v82, v113 offset:88
    v_cmp_ne_u32 s[68:69], v88, v89
    s_waitcnt vmcnt(2) lgkmcnt(0)
    v_add_u32 v115, v13, v113
    v_mfma_f32_16x16x32_bf16 v[40:43], v[72:75], v[16:19], v[84:87]
    v_mfma_f32_16x16x32_bf16 v[44:47], v[76:79], v[22:25], v[84:87]
    v_mfma_f32_4x4x4_16b_bf16 v[56:59], v[14:15], v[20:21], 0
    v_mfma_f32_4x4x4_16b_bf16 v[60:63], v[14:15], v[26:27], 0
    buffer_load_dwordx4 v[18:21], v[80:81], s[40:43], 0 idxen offen sc1
    buffer_load_dwordx4 v[24:27], v[82:83], s[40:43], 0 idxen offen sc1
    s_nop 1
    ds_read_b128 v[84:87], v89 offset:53248
    ds_read_b64 v[72:73], v114 offset:32
    ds_read_b64 v[76:77], v114 offset:48
    ds_read_u16 v80, v113 offset:104
    ds_read_u16 v82, v113 offset:120
    ds_read_u16 v112, v113 offset:74
    s_mov_b32 s65, s64
    s_setprio 3
    .p2align 5
K2_LOOP:
    s_cmp_gt_u32 s65, 16
    s_cbranch_scc1 K2_PRIO
    s_setprio 2
    s_cmp_gt_u32 s65, 8
    s_cbranch_scc1 K2_PRIO
    s_setprio 1
    s_cmp_gt_u32 s65, 4
    s_cbranch_scc1 K2_PRIO
    s_setprio 0
K2_PRIO:
    s_waitcnt vmcnt(2) lgkmcnt(3)
    v_exp_f32_e64 v40, v40 clamp
    v_mfma_f32_16x16x32_bf16 v[48:51], v[72:75], v[28:31], v[84:87]
    v_exp_f32_e64 v41, v41 clamp
    v_mfma_f32_16x16x32_bf16 v[52:55], v[76:79], v[34:37], v[84:87]
    v_exp_f32_e64 v42, v42 clamp
    v_mfma_f32_4x4x4_16b_bf16 v[64:67], v[14:15], v[32:33], 0
    v_exp_f32_e64 v43, v43 clamp
    v_mfma_f32_4x4x4_16b_bf16 v[68:71], v[14:15], v[38:39], 0
    v_exp_f32_e64 v44, v44 clamp
    s_cmp_gt_u32 s65, 3
    s_waitcnt lgkmcnt(0)
    s_cbranch_scc0 K2_SKIP0
    buffer_load_dwordx4 v[30:33], v[80:81], s[40:43], 0 idxen offen sc1
    buffer_load_dwordx4 v[36:39], v[82:83], s[40:43], 0 idxen offen sc1
K2_BACK0:
    v_exp_f32_e64 v45, v45 clamp
    v_add_u32 v90, v112, v81
    v_exp_f32_e64 v46, v46 clamp
    ds_read_b128 v[84:87], v90 offset:53248
    ds_read_b64 v[72:73], v114 offset:64
    ds_read_b64 v[76:77], v114 offset:80
    ds_read_u16 v80, v113 offset:136
    ds_read_u16 v82, v113 offset:152
    ds_read_u16 v112, v113 offset:106
    v_exp_f32_e64 v47, v47 clamp
    v_cmp_ne_u32 s[70:71], v89, v90
    v_pk_add_f32 v[40:41], v[40:41], s[66:67]
    v_pk_add_f32 v[42:43], v[42:43], s[66:67]
    v_pk_add_f32 v[44:45], v[44:45], s[66:67]
    v_pk_add_f32 v[46:47], v[46:47], s[66:67]
    v_pk_mul_f32 v[92:93], v[40:41], v[44:45]
    v_pk_mul_f32 v[94:95], v[42:43], v[46:47]
    v_pk_add_f32 v[96:97], v[40:41], v[44:45]
    v_pk_add_f32 v[98:99], v[42:43], v[46:47]
    v_pk_mul_f32 v[100:101], v[56:57], v[44:45]
    v_pk_mul_f32 v[102:103], v[58:59], v[46:47]
    v_rcp_f32 v92, v92
    v_rcp_f32 v93, v93
    v_rcp_f32 v94, v94
    v_rcp_f32 v95, v95
    v_pk_fma_f32 v[100:101], v[60:61], v[40:41], v[100:101]
    v_pk_fma_f32 v[102:103], v[62:63], v[42:43], v[102:103]
    v_pk_fma_f32 v[104:105], v[96:97], v[92:93], v[104:105]
    v_pk_fma_f32 v[106:107], v[98:99], v[94:95], v[106:107]
    v_pk_fma_f32 v[108:109], v[100:101], v[92:93], v[108:109]
    v_pk_fma_f32 v[110:111], v[102:103], v[94:95], v[110:111]
    s_sub_u32 s65, s65, 1
    s_cmp_eq_u32 s65, 0
    s_cbranch_scc1 K2_MAINDONE
    s_cmp_lg_u64 s[68:69], 0
    s_cbranch_scc1 K2_FLUSH0
K2_FBACK0:
    s_waitcnt vmcnt(2) lgkmcnt(3)
    v_exp_f32_e64 v48, v48 clamp
    v_mfma_f32_16x16x32_bf16 v[40:43], v[72:75], v[16:19], v[84:87]
    v_exp_f32_e64 v49, v49 clamp
    v_mfma_f32_16x16x32_bf16 v[44:47], v[76:79], v[22:25], v[84:87]
    v_exp_f32_e64 v50, v50 clamp
    v_mfma_f32_4x4x4_16b_bf16 v[56:59], v[14:15], v[20:21], 0
    v_exp_f32_e64 v51, v51 clamp
    v_mfma_f32_4x4x4_16b_bf16 v[60:63], v[14:15], v[26:27], 0
    v_exp_f32_e64 v52, v52 clamp
    s_cmp_gt_u32 s65, 3
    s_waitcnt lgkmcnt(0)
    s_cbranch_scc0 K2_SKIP1
    buffer_load_dwordx4 v[18:21], v[80:81], s[40:43], 0 idxen offen sc1
    buffer_load_dwordx4 v[24:27], v[82:83], s[40:43], 0 idxen offen sc1
K2_BACK1:
    v_exp_f32_e64 v53, v53 clamp
    v_add_u32 v91, v112, v81
    v_exp_f32_e64 v54, v54 clamp
    ds_read_b128 v[84:87], v91 offset:53248
    ds_read_b64 v[72:73], v114 offset:96
    ds_read_b64 v[76:77], v114 offset:112
    ds_read_u16 v80, v113 offset:168
    ds_read_u16 v82, v113 offset:184
    ds_read_u16 v112, v113 offset:138
    v_exp_f32_e64 v55, v55 clamp
    v_cmp_ne_u32 s[68:69], v90, v91
    v_pk_add_f32 v[48:49], v[48:49], s[66:67]
    v_pk_add_f32 v[50:51], v[50:51], s[66:67]
    v_pk_add_f32 v[52:53], v[52:53], s[66:67]
    v_pk_add_f32 v[54:55], v[54:55], s[66:67]
    v_pk_mul_f32 v[92:93], v[48:49], v[52:53]
    v_pk_mul_f32 v[94:95], v[50:51], v[54:55]
    v_pk_add_f32 v[96:97], v[48:49], v[52:53]
    v_pk_add_f32 v[98:99], v[50:51], v[54:55]
    v_pk_mul_f32 v[100:101], v[64:65], v[52:53]
    v_pk_mul_f32 v[102:103], v[66:67], v[54:55]
    v_rcp_f32 v92, v92
    v_rcp_f32 v93, v93
    v_rcp_f32 v94, v94
    v_rcp_f32 v95, v95
    v_pk_fma_f32 v[100:101], v[68:69], v[48:49], v[100:101]
    v_pk_fma_f32 v[102:103], v[70:71], v[50:51], v[102:103]
    v_pk_fma_f32 v[104:105], v[96:97], v[92:93], v[104:105]
    v_pk_fma_f32 v[106:107], v[98:99], v[94:95], v[106:107]
    v_pk_fma_f32 v[108:109], v[100:101], v[92:93], v[108:109]
    v_pk_fma_f32 v[110:111], v[102:103], v[94:95], v[110:111]
    s_sub_u32 s65, s65, 1
    s_cmp_eq_u32 s65, 0
    s_cbranch_scc1 K2_MAINDONE
    s_cmp_lg_u64 s[70:71], 0
    s_cbranch_scc1 K2_FLUSH1
K2_FBACK1:
    s_waitcnt vmcnt(2) lgkmcnt(3)
    v_exp_f32_e64 v40, v40 clamp
    v_mfma_f32_16x16x32_bf16 v[48:51], v[72:75], v[28:31], v[84:87]
    v_exp_f32_e64 v41, v41 clamp
    v_mfma_f32_16x16x32_bf16 v[52:55], v[76:79], v[34:37], v[84:87]
    v_exp_f32_e64 v42, v42 clamp
    v_mfma_f32_4x4x4_16b_bf16 v[64:67], v[14:15], v[32:33], 0
    v_exp_f32_e64 v43, v43 clamp
    v_mfma_f32_4x4x4_16b_bf16 v[68:71], v[14:15], v[38:39], 0
    v_exp_f32_e64 v44, v44 clamp
    s_cmp_gt_u32 s65, 3
    s_waitcnt lgkmcnt(0)
    s_cbranch_scc0 K2_SKIP2
    buffer_load_dwordx4 v[30:33], v[80:81], s[40:43], 0 idxen offen sc1
    buffer_load_dwordx4 v[36:39], v[82:83], s[40:43], 0 idxen offen sc1
K2_BACK2:
    v_exp_f32_e64 v45, v45 clamp
    v_add_u32 v88, v112, v81
    v_exp_f32_e64 v46, v46 clamp
    ds_read_b128 v[84:87], v88 offset:53248
    ds_read_b64 v[72:73], v114 offset:128
    ds_read_b64 v[76:77], v114 offset:144
    ds_read_u16 v80, v113 offset:200
    ds_read_u16 v82, v113 offset:216
    ds_read_u16 v112, v113 offset:170
    v_exp_f32_e64 v47, v47 clamp
    v_cmp_ne_u32 s[70:71], v91, v88
    v_pk_add_f32 v[40:41], v[40:41], s[66:67]
    v_pk_add_f32 v[42:43], v[42:43], s[66:67]
    v_pk_add_f32 v[44:45], v[44:45], s[66:67]
    v_pk_add_f32 v[46:47], v[46:47], s[66:67]
    v_pk_mul_f32 v[92:93], v[40:41], v[44:45]
    v_pk_mul_f32 v[94:95], v[42:43], v[46:47]
    v_pk_add_f32 v[96:97], v[40:41], v[44:45]
    v_pk_add_f32 v[98:99], v[42:43], v[46:47]
    v_pk_mul_f32 v[100:101], v[56:57], v[44:45]
    v_pk_mul_f32 v[102:103], v[58:59], v[46:47]
    v_rcp_f32 v92, v92
    v_rcp_f32 v93, v93
    v_rcp_f32 v94, v94
    v_rcp_f32 v95, v95
    v_pk_fma_f32 v[100:101], v[60:61], v[40:41], v[100:101]
    v_pk_fma_f32 v[102:103], v[62:63], v[42:43], v[102:103]
    v_pk_fma_f32 v[104:105], v[96:97], v[92:93], v[104:105]
    v_pk_fma_f32 v[106:107], v[98:99], v[94:95], v[106:107]
    v_pk_fma_f32 v[108:109], v[100:101], v[92:93], v[108:109]
    v_pk_fma_f32 v[110:111], v[102:103], v[94:95], v[110:111]
    s_sub_u32 s65, s65, 1
    s_cmp_eq_u32 s65, 0
    s_cbranch_scc1 K2_MAINDONE
    s_cmp_lg_u64 s[68:69], 0
    s_cbranch_scc1 K2_FLUSH2
K2_FBACK2:
    s_waitcnt vmcnt(2) lgkmcnt(3)
    v_exp_f32_e64 v48, v48 clamp
    v_mfma_f32_16x16x32_bf16 v[40:43], v[72:75], v[16:19], v[84:87]
    v_exp_f32_e64 v49, v49 clamp
    v_mfma_f32_16x16x32_bf16 v[44:47], v[76:79], v[22:25], v[84:87]
    v_exp_f32_e64 v50, v50 clamp
    v_mfma_f32_4x4x4_16b_bf16 v[56:59], v[14:15], v[20:21], 0
    v_exp_f32_e64 v51, v51 clamp
    v_mfma_f32_4x4x4_16b_bf16 v[60:63], v[14:15], v[26:27], 0
    v_exp_f32_e64 v52, v52 clamp
    s_cmp_gt_u32 s65, 3
    s_waitcnt lgkmcnt(0)
    s_cbranch_scc0 K2_SKIP3
    buffer_load_dwordx4 v[18:21], v[80:81], s[40:43], 0 idxen offen sc1
    buffer_load_dwordx4 v[24:27], v[82:83], s[40:43], 0 idxen offen sc1
K2_BACK3:
    v_exp_f32_e64 v53, v53 clamp
    v_add_u32 v89, v112, v81
    v_exp_f32_e64 v54, v54 clamp
    ds_read_b128 v[84:87], v89 offset:53248
    ds_read_b64 v[72:73], v114 offset:160
    ds_read_b64 v[76:77], v114 offset:176
    ds_read_u16 v80, v113 offset:232
    ds_read_u16 v82, v113 offset:248
    ds_read_u16 v112, v113 offset:202
    v_exp_f32_e64 v55, v55 clamp
    v_cmp_ne_u32 s[68:69], v88, v89
    v_pk_add_f32 v[48:49], v[48:49], s[66:67]
    v_pk_add_f32 v[50:51], v[50:51], s[66:67]
    v_pk_add_f32 v[52:53], v[52:53], s[66:67]
    v_pk_add_f32 v[54:55], v[54:55], s[66:67]
    v_pk_mul_f32 v[92:93], v[48:49], v[52:53]
    v_pk_mul_f32 v[94:95], v[50:51], v[54:55]
    v_pk_add_f32 v[96:97], v[48:49], v[52:53]
    v_pk_add_f32 v[98:99], v[50:51], v[54:55]
    v_pk_mul_f32 v[100:101], v[64:65], v[52:53]
    v_pk_mul_f32 v[102:103], v[66:67], v[54:55]
    v_rcp_f32 v92, v92
    v_rcp_f32 v93, v93
    v_rcp_f32 v94, v94
    v_rcp_f32 v95, v95
    v_pk_fma_f32 v[100:101], v[68:69], v[48:49], v[100:101]
    v_pk_fma_f32 v[102:103], v[70:71], v[50:51], v[102:103]
    v_add_u32 v113, 0x80, v113
    v_add_u32 v114, v12, v114
    v_pk_fma_f32 v[104:105], v[96:97], v[92:93], v[104:105]
    v_pk_fma_f32 v[106:107], v[98:99], v[94:95], v[106:107]
    v_pk_fma_f32 v[108:109], v[100:101], v[92:93], v[108:109]
    v_pk_fma_f32 v[110:111], v[102:103], v[94:95], v[110:111]
    s_sub_u32 s65, s65, 1
    s_cmp_eq_u32 s65, 0
    s_cbranch_scc1 K2_MAINDONE
    s_cmp_lg_u64 s[70:71], 0
    s_cbranch_scc1 K2_FLUSH3
    s_branch K2_LOOP
K2_SKIP0:
    s_waitcnt vmcnt(0)
    s_branch K2_BACK0
K2_FLUSH0:
    s_mov_b64 exec, s[68:69]
    v_sub_u32 v13, v88, v11
    ds_write_b32 v13, v104 offset:2560
    ds_write_b32 v13, v105 offset:2624
    ds_write_b32 v13, v106 offset:2688
    ds_write_b32 v13, v107 offset:2752
    ds_write_b32 v13, v108 offset:27904
    ds_write_b32 v13, v109 offset:27968
    ds_write_b32 v13, v110 offset:28032
    ds_write_b32 v13, v111 offset:28096
    ds_read_b128 v[104:107], v10
    ds_read_b128 v[108:111], v10
    s_mov_b64 exec, -1
    s_branch K2_FBACK0
K2_SKIP1:
    s_waitcnt vmcnt(0)
    s_branch K2_BACK1
K2_FLUSH1:
    s_mov_b64 exec, s[70:71]
    v_sub_u32 v13, v89, v11
    ds_write_b32 v13, v104 offset:2560
    ds_write_b32 v13, v105 offset:2624
    ds_write_b32 v13, v106 offset:2688
    ds_write_b32 v13, v107 offset:2752
    ds_write_b32 v13, v108 offset:27904
    ds_write_b32 v13, v109 offset:27968
    ds_write_b32 v13, v110 offset:28032
    ds_write_b32 v13, v111 offset:28096
    ds_read_b128 v[104:107], v10
    ds_read_b128 v[108:111], v10
    s_mov_b64 exec, -1
    s_branch K2_FBACK1
K2_SKIP2:
    s_waitcnt vmcnt(0)
    s_branch K2_BACK2
K2_FLUSH2:
    s_mov_b64 exec, s[68:69]
    v_sub_u32 v13, v90, v11
    ds_write_b32 v13, v104 offset:2560
    ds_write_b32 v13, v105 offset:2624
    ds_write_b32 v13, v106 offset:2688
    ds_write_b32 v13, v107 offset:2752
    ds_write_b32 v13, v108 offset:27904
    ds_write_b32 v13, v109 offset:27968
    ds_write_b32 v13, v110 offset:28032
    ds_write_b32 v13, v111 offset:28096
    ds_read_b128 v[104:107], v10
    ds_read_b128 v[108:111], v10
    s_mov_b64 exec, -1
    s_branch K2_FBACK2
K2_SKIP3:
    s_waitcnt vmcnt(0)
    s_branch K2_BACK3
K2_FLUSH3:
    s_mov_b64 exec, s[70:71]
    v_sub_u32 v13, v91, v11
    ds_write_b32 v13, v104 offset:2560
    ds_write_b32 v13, v105 offset:2624
    ds_write_b32 v13, v106 offset:2688
    ds_write_b32 v13, v107 offset:2752
    ds_write_b32 v13, v108 offset:27904
    ds_write_b32 v13, v109 offset:27968
    ds_write_b32 v13, v110 offset:28032
    ds_write_b32 v13, v111 offset:28096
    ds_read_b128 v[104:107], v10
    ds_read_b128 v[108:111], v10
    s_mov_b64 exec, -1
    s_branch K2_LOOP
K2_TOOMANY:
    s_cmp_eq_u32 s61, 16
    s_cbranch_scc1 K2_END
    s_waitcnt lgkmcnt(0)
    s_barrier
    s_movk_i32 s58, 33
    v_cmp_gt_u32 vcc, s58, v0
    v_mov_b64 v[120:121], 0
    v_mov_b64 v[122:123], 0
    s_mov_b64 exec, vcc
    ds_write_b128 v8, v[120:123] offset:1024
    s_mov_b64 exec, -1
    s_mov_b32 s61, 16
    s_waitcnt lgkmcnt(0)
    s_barrier
    s_branch K2_RANK
K2_MAINDONE:
    s_waitcnt lgkmcnt(0)
    ds_write_b32 v115, v104 offset:0
    ds_write_b32 v115, v105 offset:64
    ds_write_b32 v115, v106 offset:128
    ds_write_b32 v115, v107 offset:192
    ds_write_b32 v115, v108 offset:256
    ds_write_b32 v115, v109 offset:320
    ds_write_b32 v115, v110 offset:384
    ds_write_b32 v115, v111 offset:448
    v_lshrrev_b32 v13, 3, v0
    v_lshlrev_b32 v84, 2, v13
    v_add_u32 v84, 2048, v84
    ds_read2_b32 v[86:87], v84 offset0:0 offset1:1
    v_and_b32 v88, 7, v0
    v_mul_u32_u24 v89, 144, v13
    v_lshl_add_u32 v89, v88, 4, v89
    v_add_u32 v89, 78848, v89
    v_min_u32 v89, 93104, v89
    ds_read_b128 v[56:59], v89
    v_cvt_f32_u32 v90, s64
    v_rcp_f32 v90, v90
    s_movk_i32 s58, 784
    v_cmp_gt_u32 vcc, s58, v0
    v_mul_f32 v90, 0x49800000, v90
    v_cvt_u32_f32 v90, v90
    v_add_u32 v90, 1, v90
    v_lshlrev_b32 v88, 5, v88
    v_lshl_or_b32 v84, v13, 8, v88
    s_lshl_b32 s59, s64, 5
    v_lshlrev_b32 v60, 16, v4
    v_and_b32 v61, 0xffff0000, v4
    v_lshlrev_b32 v62, 16, v5
    v_and_b32 v63, 0xffff0000, v5
    v_lshlrev_b32 v64, 16, v6
    v_and_b32 v65, 0xffff0000, v6
    v_lshlrev_b32 v66, 16, v7
    v_and_b32 v67, 0xffff0000, v7
    s_waitcnt lgkmcnt(1)
    v_cmp_lt_u32 s[70:71], v86, v87
    v_subrev_u32 v86, 93440, v86
    v_lshrrev_b32 v89, 5, v86
    v_mul_u32_u24 v86, v89, v90
    v_lshrrev_b32 v86, 20, v86
    v_subrev_u32 v87, 93440, v87
    v_lshrrev_b32 v89, 5, v87
    v_mul_u32_u24 v87, v89, v90
    v_lshrrev_b32 v87, 20, v87
    v_mul_u32_u24 v90, s64, v87
    v_cmp_ne_u32 s[68:69], v89, v90
    v_mov_b64 v[40:41], 0
    v_mov_b64 v[42:43], 0
    v_mov_b64 v[44:45], 0
    v_mov_b64 v[46:47], 0
    v_mov_b64 v[48:49], 0
    v_mov_b64 v[50:51], 0
    v_mov_b64 v[52:53], 0
    v_mov_b64 v[54:55], 0
    s_and_b64 s[70:71], s[70:71], s[68:69]
    v_sub_u32 v87, v87, v86
    v_mad_u32_u24 v86, v86, s59, v88
    v_add_u32 v86, 93440, v86
    s_waitcnt lgkmcnt(0)
    v_lshlrev_b32 v116, 16, v56
    v_and_b32 v117, 0xffff0000, v56
    v_lshlrev_b32 v118, 16, v57
    v_and_b32 v119, 0xffff0000, v57
    v_lshlrev_b32 v120, 16, v58
    v_and_b32 v121, 0xffff0000, v58
    v_lshlrev_b32 v122, 16, v59
    v_and_b32 v123, 0xffff0000, v59
    s_mov_b32 s76, 0x498637bd
    s_mov_b32 s77, s76
    s_mov_b64 s[68:69], vcc
    s_waitcnt vmcnt(0)
    s_barrier
    s_and_b64 exec, vcc, s[70:71]
    ds_read_b128 v[40:43], v84 offset:2560
    ds_read_b128 v[44:47], v84 offset:2576
    ds_read_b128 v[48:51], v84 offset:27904
    ds_read_b128 v[52:55], v84 offset:27920
    s_mov_b64 exec, vcc
K2_TAILS:
    v_cmpx_lt_i32 vcc, 0, v87
    s_cbranch_execz K2_TAILSDONE
    ds_read_b128 v[92:95], v86
    ds_read_b128 v[96:99], v86 offset:16
    ds_read_b128 v[100:103], v86 offset:256
    ds_read_b128 v[104:107], v86 offset:272
    v_add_u32 v86, s59, v86
    v_subrev_u32 v87, 1, v87
    s_waitcnt lgkmcnt(3)
    v_pk_add_f32 v[40:41], v[40:41], v[92:93]
    v_pk_add_f32 v[42:43], v[42:43], v[94:95]
    s_waitcnt lgkmcnt(2)
    v_pk_add_f32 v[44:45], v[44:45], v[96:97]
    v_pk_add_f32 v[46:47], v[46:47], v[98:99]
    s_waitcnt lgkmcnt(1)
    v_pk_add_f32 v[48:49], v[48:49], v[100:101]
    v_pk_add_f32 v[50:51], v[50:51], v[102:103]
    s_waitcnt lgkmcnt(0)
    v_pk_add_f32 v[52:53], v[52:53], v[104:105]
    v_pk_add_f32 v[54:55], v[54:55], v[106:107]
    s_branch K2_TAILS
K2_TAILSDONE:
    s_mov_b64 exec, s[68:69]
    s_or_b32 s58, s60, s63
    s_cmp_lg_u32 s58, 0
    s_cbranch_scc1 K2_MULTI
K2_FINAL:
    s_waitcnt lgkmcnt(2)
    v_pk_add_f32 v[40:41], v[40:41], s[76:77]
    v_pk_add_f32 v[42:43], v[42:43], s[76:77]
    v_pk_add_f32 v[44:45], v[44:45], s[76:77]
    v_pk_add_f32 v[46:47], v[46:47], s[76:77]
    v_rcp_f32 v40, v40
    v_rcp_f32 v41, v41
    v_rcp_f32 v42, v42
    v_rcp_f32 v43, v43
    v_rcp_f32 v44, v44
    v_rcp_f32 v45, v45
    v_rcp_f32 v46, v46
    v_rcp_f32 v47, v47
    s_waitcnt lgkmcnt(0)
    v_pk_fma_f32 v[116:117], v[48:49], v[40:41], v[116:117]
    v_pk_fma_f32 v[118:119], v[50:51], v[42:43], v[118:119]
    v_pk_fma_f32 v[120:121], v[52:53], v[44:45], v[120:121]
    v_pk_fma_f32 v[122:123], v[54:55], v[46:47], v[122:123]
    v_max_f32 v116, 0, v116
    v_max_f32 v117, 0, v117
    v_max_f32 v118, 0, v118
    v_max_f32 v119, 0, v119
    v_max_f32 v120, 0, v120
    v_max_f32 v121, 0, v121
    v_max_f32 v122, 0, v122
    v_max_f32 v123, 0, v123
    v_pk_add_f32 v[60:61], v[60:61], v[116:117]
    v_pk_add_f32 v[62:63], v[62:63], v[118:119]
    v_pk_add_f32 v[64:65], v[64:65], v[120:121]
    v_pk_add_f32 v[66:67], v[66:67], v[122:123]
    v_cvt_pk_bf16_f32 v40, v60, v61
    v_cvt_pk_bf16_f32 v41, v62, v63
    v_cvt_pk_bf16_f32 v42, v64, v65
    v_cvt_pk_bf16_f32 v43, v66, v67
    buffer_store_dwordx4 v[40:43], v9, s[48:51], s57 offen
K2_END:
    s_endpgm
K2_MULTI:
    s_lshl_b32 s58, s2, 16
    s_add_u32 s58, s58, 67108864
    s_add_u32 s28, s26, s58
    s_addc_u32 s29, s27, 0
    s_and_b32 s29, s29, 0xffff
    s_mov_b32 s30, 65536
    s_mov_b32 s31, 0x00020000
    v_lshlrev_b32 v88, 2, v8
    s_waitcnt lgkmcnt(0)
    s_cmp_eq_u32 s60, 0
    s_cbranch_scc1 K2_NOSPILLIN
    buffer_load_dwordx4 v[92:95], v88, s[28:31], 0 offen offset:0 sc1
    buffer_load_dwordx4 v[96:99], v88, s[28:31], 0 offen offset:16 sc1
    buffer_load_dwordx4 v[100:103], v88, s[28:31], 0 offen offset:32 sc1
    buffer_load_dwordx4 v[104:107], v88, s[28:31], 0 offen offset:48 sc1
    s_waitcnt vmcnt(0)
    v_pk_add_f32 v[40:41], v[40:41], v[92:93]
    v_pk_add_f32 v[42:43], v[42:43], v[94:95]
    v_pk_add_f32 v[44:45], v[44:45], v[96:97]
    v_pk_add_f32 v[46:47], v[46:47], v[98:99]
    v_pk_add_f32 v[48:49], v[48:49], v[100:101]
    v_pk_add_f32 v[50:51], v[50:51], v[102:103]
    v_pk_add_f32 v[52:53], v[52:53], v[104:105]
    v_pk_add_f32 v[54:55], v[54:55], v[106:107]
K2_NOSPILLIN:
    s_cmp_eq_u32 s63, 0
    s_cbranch_scc1 K2_FINAL
    buffer_store_dwordx4 v[40:43], v88, s[28:31], 0 offen offset:0 sc1
    buffer_store_dwordx4 v[44:47], v88, s[28:31], 0 offen offset:16 sc1
    buffer_store_dwordx4 v[48:51], v88, s[28:31], 0 offen offset:32 sc1
    buffer_store_dwordx4 v[52:55], v88, s[28:31], 0 offen offset:48 sc1
    s_mov_b64 exec, -1
    v_mov_b64 v[120:121], 0
    v_mov_b64 v[122:123], 0
    s_movk_i32 s58, 33
    v_cmp_gt_u32 vcc, s58, v0
    s_mov_b64 exec, vcc
    ds_write_b128 v8, v[120:123] offset:1024
    s_mov_b64 exec, -1
    s_mul_i32 s58, s61, 12
    v_subrev_u32 v3, s61, v3
    v_add_u32 v2, s58, v2
    v_subrev_u32 v127, s61, v127
    v_add_u32 v126, s58, v126
    s_add_u32 s60, s60, 1
    s_setprio 0
    s_waitcnt vmcnt(0) lgkmcnt(0)
    s_barrier
    s_cmp_le_u32 s60, 128
    s_cbranch_scc1 K2_ROUND
    s_endpgm
F_LAST:
.section .rodata,"a"
.p2align 6
.amdhsa_kernel standalone__edge_featured_mpnn_gatedgcn__graph_kernel
  .amdhsa_next_free_vgpr 128
  .amdhsa_next_free_sgpr 80
  .amdhsa_accum_offset 128
  .amdhsa_group_segment_fixed_size 0
  .amdhsa_kernarg_size 96
  .amdhsa_user_sgpr_count 2
  .amdhsa_user_sgpr_kernarg_segment_ptr 1
  .amdhsa_system_sgpr_workgroup_id_x 1
  .amdhsa_float_denorm_mode_32 3
.end_amdhsa_kernel
```
